```python
import torch

def _softmax(x, axis=-1):
    return torch.softmax(x, dim=axis)
def _gelu(x):
    return torch.nn.functional.gelu(x, approximate="tanh")
def _silu(x):
    return torch.nn.functional.silu(x)
def _sigmoid(x):
    return torch.sigmoid(x)
def _layernorm(x, axis=-1, eps=1e-5):
    m = x.mean(dim=axis, keepdim=True)
    v = x.var(dim=axis, keepdim=True, unbiased=False)
    return (x - m) / torch.sqrt(v + eps)
def _scatter_add(tgt, idx, src, axis=0):
    return tgt.clone().index_add_(axis, idx, src)
def _segment_sum(src, seg, n):
    out = torch.zeros((n,) + src.shape[1:], dtype=src.dtype)
    return out.index_add_(0, seg, src)
def _pad(x, pw):
    flat = tuple(v for pair in reversed(pw) for v in pair)
    return torch.nn.functional.pad(x, flat)

kernel_name = 'parallel_sum__mha_block__dense_activation_squared_relu__prompt'

def setup_inputs():

    _w = (lambda a: (lambda t: t.to(torch.bfloat16) if t.is_floating_point() else t)(torch.as_tensor(a)))
    def _A_setup():
        B, S, D, H = 1, 2048, 448, 16
        return {
            "x": _w((lambda *s: torch.randn(*s, dtype=torch.bfloat16) * 0.05)(B, S, D)),
            "wqkv": _w((lambda *s: torch.randn(*s, dtype=torch.bfloat16) * 0.2)(D, 3 * D)),
            "wo": _w((lambda *s: torch.randn(*s, dtype=torch.bfloat16) * 0.1)(D, D)),
        }
    _A_in = _A_setup()

    def _B_setup():
        B, S, D, F = 1, 2048, 448, 1792
        return {
            "x": _w((lambda *s: torch.randn(*s, dtype=torch.bfloat16) * 0.05)(B, S, D)),
            "w1": _w((lambda *s: torch.randn(*s, dtype=torch.bfloat16) * 0.1)(D, F)),
            "b1": _w((lambda *s: torch.randn(*s, dtype=torch.bfloat16) * 0.8)(F)),
            "w2": _w((lambda *s: torch.randn(*s, dtype=torch.bfloat16) * 0.1)(F, D)),
            "b2": _w((lambda *s: torch.randn(*s, dtype=torch.bfloat16) * 12.8)(D)),
        }
    _B_in = _B_setup()

    return {
        "A_x": _A_in["x"],
        "A_wqkv": _A_in["wqkv"],
        "A_wo": _A_in["wo"],
        "B_x": _B_in["x"],
        "B_w1": _B_in["w1"],
        "B_b1": _B_in["b1"],
        "B_w2": _B_in["w2"],
        "B_b2": _B_in["b2"],
    }

def reference(A_x, A_wqkv, A_wo, B_x, B_w1, B_b1, B_w2, B_b2):
    def _A_ref(x, wqkv, wo):
        B, S, D = x.shape
        H = 16
        Dh = D // H
        qkv = (lambda x, *d: x.permute(*d))((x @ wqkv).reshape(B, S, 3, H, Dh), 2, 0, 3, 1, 4)
        q, k, v = qkv[0], qkv[1], qkv[2]
        scores = torch.einsum("bhqd,bhkd->bhqk", q, k) * (Dh ** -0.5)
        p = _softmax(scores, axis=-1)
        o = torch.einsum("bhqk,bhkd->bhqd", p, v)
        return (lambda x, *d: x.permute(*d))(o, 0, 2, 1, 3).reshape(B, S, D) @ wo

    def _B_ref(x, w1, b1, w2, b2):
        h = torch.einsum("bsd,df->bsf", x, w1) + b1
        zero = torch.zeros_like(h)
        r = torch.where(h > zero, h, zero)
        h = r * r
        out = torch.einsum("bsf,fd->bsd", h, w2) + b2
        return out

    x = A_x
    xn = _layernorm(x, axis=-1)
    return x + _A_ref(xn, A_wqkv, A_wo) + _B_ref(xn, B_w1, B_b1, B_w2, B_b2)
```

```asm
; @launch grid=(256,1,1) block=(768,1,1) lds=163840
.amdgcn_target "amdgcn-amd-amdhsa--gfx950"
.text
.globl parallel_sum__mha_block__dense_activation_squared_relu__prompt_kernel
.p2align 8
.type parallel_sum__mha_block__dense_activation_squared_relu__prompt_kernel,@function
parallel_sum__mha_block__dense_activation_squared_relu__prompt_kernel:
    s_cmp_ge_u32 s2, 256
    s_cbranch_scc1 L_exit
    s_load_dwordx4 s[48:51], s[0:1], 0
    s_load_dwordx2 s[66:67], s[0:1], 80
    s_load_dwordx4 s[56:59], s[0:1], 32
    s_load_dwordx2 s[52:53], s[0:1], 16
    s_load_dwordx4 s[60:63], s[0:1], 48
    s_load_dwordx2 s[64:65], s[0:1], 64
    v_lshrrev_b32 v2, 6, v0
    v_and_b32 v1, 63, v0
    v_readfirstlane_b32 s3, v2
    s_and_b32 s68, s2, 7
    s_lshl_b32 s68, s68, 1
    s_bfe_u32 s69, s2, 0x10003
    s_add_u32 s4, s68, s69
    s_lshr_b32 s5, s2, 4
    s_cmp_ge_u32 s3, 8
    s_cbranch_scc1 L_aux
    s_and_b32 s6, s3, 3
    s_lshr_b32 s7, s3, 2
    v_lshrrev_b32 v2, 3, v1
    v_and_b32 v3, 7, v1
    v_mul_u32_u24 v4, 896, v2
    v_lshl_add_u32 v4, v3, 4, v4
    s_lshl_b32 s68, s5, 7
    s_lshl_b32 s69, s6, 5
    s_add_u32 s68, s68, s69
    s_lshl_b32 s69, s7, 4
    s_add_u32 s68, s68, s69
    s_mul_i32 s68, s68, 896
    s_add_u32 s69, s68, 7168
    s_waitcnt lgkmcnt(0)
    s_mov_b32 s8, s48
    s_mov_b32 s9, s49
    s_mov_b32 s10, 1835008
    s_mov_b32 s11, 0x00020000
    buffer_load_dwordx4 v[112:115], v4, s[8:11], s68 offen offset:0
    buffer_load_dwordx4 v[116:119], v4, s[8:11], s68 offen offset:128
    buffer_load_dwordx4 v[120:123], v4, s[8:11], s68 offen offset:256
    buffer_load_dwordx4 v[124:127], v4, s[8:11], s68 offen offset:384
    buffer_load_dwordx4 v[128:131], v4, s[8:11], s68 offen offset:512
    buffer_load_dwordx4 v[132:135], v4, s[8:11], s68 offen offset:640
    buffer_load_dwordx4 v[136:139], v4, s[8:11], s68 offen offset:768
    buffer_load_dwordx4 v[140:143], v4, s[8:11], s69 offen offset:0
    buffer_load_dwordx4 v[144:147], v4, s[8:11], s69 offen offset:128
    buffer_load_dwordx4 v[148:151], v4, s[8:11], s69 offen offset:256
    buffer_load_dwordx4 v[152:155], v4, s[8:11], s69 offen offset:384
    buffer_load_dwordx4 v[156:159], v4, s[8:11], s69 offen offset:512
    buffer_load_dwordx4 v[160:163], v4, s[8:11], s69 offen offset:640
    buffer_load_dwordx4 v[164:167], v4, s[8:11], s69 offen offset:768
    s_barrier
    s_load_dwordx2 s[44:45], s[66:67], 196608
    s_mov_b32 s40, s66
    s_mov_b32 s41, s67
    s_mov_b32 s42, 268435456
    s_mov_b32 s43, 0x00020000
    s_mov_b32 s20, s56
    s_mov_b32 s21, s57
    s_mov_b32 s22, 1605632
    s_mov_b32 s23, 0x00020000
    s_mov_b32 s12, s50
    s_mov_b32 s13, s51
    s_mov_b32 s14, 1204224
    s_mov_b32 s15, 0x00020000
    s_lshr_b32 s46, 0x15ab, s4
    s_and_b32 s46, s46, 1
    s_lshl_b32 s74, 1, s4
    s_sub_u32 s74, s74, 1
    s_and_b32 s74, s74, 0x15ab
    s_bcnt1_i32_b32 s74, s74
    s_cmp_eq_u32 s46, 1
    s_cbranch_scc0 L_1
    s_lshl_b32 s72, s74, 2
    s_add_u32 s73, s72, 2
    s_branch L_2
L_1:
    s_sub_u32 s74, s4, s74
    s_mul_i32 s72, s74, 3
    s_add_u32 s72, s72, 32
    s_and_b32 s74, s74, 1
    s_add_u32 s73, s72, 2
    s_cmp_eq_u32 s74, 0
    s_cselect_b32 s73, s73, s72
    s_add_u32 s72, s72, s74
L_2:
    v_lshrrev_b32 v2, 3, v1
    s_lshl_b32 s78, s7, 4
    v_add_u32 v2, s78, v2
    v_and_b32 v3, 7, v1
    v_and_b32 v5, 1, v1
    v_lshl_add_u32 v2, v5, 5, v2
    v_xor_b32 v2, v2, v3
    v_lshlrev_b32 v2, 4, v2
    v_lshrrev_b32 v3, 1, v3
    v_lshl_add_u32 v2, v3, 10, v2
    s_mul_i32 s79, s6, 28672
    v_add_u32 v5, s79, v2
    v_lshrrev_b32 v3, 5, v1
    v_add_u32 v2, 0, v3
    v_xor_b32 v2, v2, v1
    v_lshlrev_b32 v2, 4, v2
    v_add_u32 v8, s79, v2
    v_add_u32 v2, 2, v3
    v_xor_b32 v2, v2, v1
    v_lshlrev_b32 v2, 4, v2
    v_add_u32 v9, s79, v2
    v_add_u32 v2, 4, v3
    v_xor_b32 v2, v2, v1
    v_lshlrev_b32 v2, 4, v2
    v_add_u32 v10, s79, v2
    v_add_u32 v2, 6, v3
    v_xor_b32 v2, v2, v1
    v_lshlrev_b32 v2, 4, v2
    v_add_u32 v11, s79, v2
    s_waitcnt lgkmcnt(0)
    s_mul_i32 s44, s44, 0x9E3779B2
    s_add_u32 s44, s44, 0x7F4A7C15
    s_xor_b32 s45, s45, s44
    s_mul_i32 s45, s45, 0x85EBCA6A
    s_add_u32 s45, s45, 0x2545F491
    s_mov_b32 s87, 0x3f803f80
    s_waitcnt vmcnt(7)
    v_mov_b32 v24, 0
    v_mov_b32 v25, 0
    v_mov_b32 v26, 0
    v_mov_b32 v27, 0
    v_dot2_f32_bf16 v24, v112, s87, v24
    v_dot2_f32_bf16 v26, v112, v112, v26
    v_dot2_f32_bf16 v25, v113, s87, v25
    v_dot2_f32_bf16 v27, v113, v113, v27
    v_dot2_f32_bf16 v24, v114, s87, v24
    v_dot2_f32_bf16 v26, v114, v114, v26
    v_dot2_f32_bf16 v25, v115, s87, v25
    v_dot2_f32_bf16 v27, v115, v115, v27
    v_dot2_f32_bf16 v24, v116, s87, v24
    v_dot2_f32_bf16 v26, v116, v116, v26
    v_dot2_f32_bf16 v25, v117, s87, v25
    v_dot2_f32_bf16 v27, v117, v117, v27
    v_dot2_f32_bf16 v24, v118, s87, v24
    v_dot2_f32_bf16 v26, v118, v118, v26
    v_dot2_f32_bf16 v25, v119, s87, v25
    v_dot2_f32_bf16 v27, v119, v119, v27
    v_dot2_f32_bf16 v24, v120, s87, v24
    v_dot2_f32_bf16 v26, v120, v120, v26
    v_dot2_f32_bf16 v25, v121, s87, v25
    v_dot2_f32_bf16 v27, v121, v121, v27
    v_dot2_f32_bf16 v24, v122, s87, v24
    v_dot2_f32_bf16 v26, v122, v122, v26
    v_dot2_f32_bf16 v25, v123, s87, v25
    v_dot2_f32_bf16 v27, v123, v123, v27
    v_dot2_f32_bf16 v24, v124, s87, v24
    v_dot2_f32_bf16 v26, v124, v124, v26
    v_dot2_f32_bf16 v25, v125, s87, v25
    v_dot2_f32_bf16 v27, v125, v125, v27
    v_dot2_f32_bf16 v24, v126, s87, v24
    v_dot2_f32_bf16 v26, v126, v126, v26
    v_dot2_f32_bf16 v25, v127, s87, v25
    v_dot2_f32_bf16 v27, v127, v127, v27
    v_dot2_f32_bf16 v24, v128, s87, v24
    v_dot2_f32_bf16 v26, v128, v128, v26
    v_dot2_f32_bf16 v25, v129, s87, v25
    v_dot2_f32_bf16 v27, v129, v129, v27
    v_dot2_f32_bf16 v24, v130, s87, v24
    v_dot2_f32_bf16 v26, v130, v130, v26
    v_dot2_f32_bf16 v25, v131, s87, v25
    v_dot2_f32_bf16 v27, v131, v131, v27
    v_dot2_f32_bf16 v24, v132, s87, v24
    v_dot2_f32_bf16 v26, v132, v132, v26
    v_dot2_f32_bf16 v25, v133, s87, v25
    v_dot2_f32_bf16 v27, v133, v133, v27
    v_dot2_f32_bf16 v24, v134, s87, v24
    v_dot2_f32_bf16 v26, v134, v134, v26
    v_dot2_f32_bf16 v25, v135, s87, v25
    v_dot2_f32_bf16 v27, v135, v135, v27
    v_dot2_f32_bf16 v24, v136, s87, v24
    v_dot2_f32_bf16 v26, v136, v136, v26
    v_dot2_f32_bf16 v25, v137, s87, v25
    v_dot2_f32_bf16 v27, v137, v137, v27
    v_dot2_f32_bf16 v24, v138, s87, v24
    v_dot2_f32_bf16 v26, v138, v138, v26
    v_dot2_f32_bf16 v25, v139, s87, v25
    v_dot2_f32_bf16 v27, v139, v139, v27
    s_nop 1
    v_add_f32 v24, v24, v25
    v_add_f32 v26, v26, v27
    s_nop 0
    v_add_f32_dpp v24, v24, v24 quad_perm:[1,0,3,2] row_mask:0xf bank_mask:0xf
    v_add_f32_dpp v26, v26, v26 quad_perm:[1,0,3,2] row_mask:0xf bank_mask:0xf
    s_nop 0
    v_add_f32_dpp v24, v24, v24 quad_perm:[2,3,0,1] row_mask:0xf bank_mask:0xf
    v_add_f32_dpp v26, v26, v26 quad_perm:[2,3,0,1] row_mask:0xf bank_mask:0xf
    s_nop 0
    v_add_f32_dpp v24, v24, v24 row_half_mirror row_mask:0xf bank_mask:0xf
    v_add_f32_dpp v26, v26, v26 row_half_mirror row_mask:0xf bank_mask:0xf
    v_mul_f32 v24, 0x3b124925, v24
    v_mul_f32 v26, 0x3b124925, v26
    v_fma_f32 v26, -v24, v24, v26
    v_max_f32 v26, 0, v26
    v_add_f32 v26, 0x3727c5ac, v26
    v_rsq_f32 v28, v26
    s_nop 0
    v_mul_f32_e64 v30, -v24, v28
    v_lshlrev_b32 v32, 16, v112
    v_and_b32 v33, 0xffff0000, v112
    v_pk_fma_f32 v[32:33], v[32:33], v[28:29], v[30:31] op_sel_hi:[1,0,0]
    v_cvt_pk_bf16_f32 v112, v32, v33
    v_lshlrev_b32 v34, 16, v113
    v_and_b32 v35, 0xffff0000, v113
    v_pk_fma_f32 v[34:35], v[34:35], v[28:29], v[30:31] op_sel_hi:[1,0,0]
    v_cvt_pk_bf16_f32 v113, v34, v35
    v_lshlrev_b32 v36, 16, v114
    v_and_b32 v37, 0xffff0000, v114
    v_pk_fma_f32 v[36:37], v[36:37], v[28:29], v[30:31] op_sel_hi:[1,0,0]
    v_cvt_pk_bf16_f32 v114, v36, v37
    v_lshlrev_b32 v38, 16, v115
    v_and_b32 v39, 0xffff0000, v115
    v_pk_fma_f32 v[38:39], v[38:39], v[28:29], v[30:31] op_sel_hi:[1,0,0]
    v_cvt_pk_bf16_f32 v115, v38, v39
    ds_write_b128 v5, v[112:115] offset:0
    v_lshlrev_b32 v32, 16, v116
    v_and_b32 v33, 0xffff0000, v116
    v_pk_fma_f32 v[32:33], v[32:33], v[28:29], v[30:31] op_sel_hi:[1,0,0]
    v_cvt_pk_bf16_f32 v116, v32, v33
    v_lshlrev_b32 v34, 16, v117
    v_and_b32 v35, 0xffff0000, v117
    v_pk_fma_f32 v[34:35], v[34:35], v[28:29], v[30:31] op_sel_hi:[1,0,0]
    v_cvt_pk_bf16_f32 v117, v34, v35
    v_lshlrev_b32 v36, 16, v118
    v_and_b32 v37, 0xffff0000, v118
    v_pk_fma_f32 v[36:37], v[36:37], v[28:29], v[30:31] op_sel_hi:[1,0,0]
    v_cvt_pk_bf16_f32 v118, v36, v37
    v_lshlrev_b32 v38, 16, v119
    v_and_b32 v39, 0xffff0000, v119
    v_pk_fma_f32 v[38:39], v[38:39], v[28:29], v[30:31] op_sel_hi:[1,0,0]
    v_cvt_pk_bf16_f32 v119, v38, v39
    ds_write_b128 v5, v[116:119] offset:4096
    v_lshlrev_b32 v32, 16, v120
    v_and_b32 v33, 0xffff0000, v120
    v_pk_fma_f32 v[32:33], v[32:33], v[28:29], v[30:31] op_sel_hi:[1,0,0]
    v_cvt_pk_bf16_f32 v120, v32, v33
    v_lshlrev_b32 v34, 16, v121
    v_and_b32 v35, 0xffff0000, v121
    v_pk_fma_f32 v[34:35], v[34:35], v[28:29], v[30:31] op_sel_hi:[1,0,0]
    v_cvt_pk_bf16_f32 v121, v34, v35
    v_lshlrev_b32 v36, 16, v122
    v_and_b32 v37, 0xffff0000, v122
    v_pk_fma_f32 v[36:37], v[36:37], v[28:29], v[30:31] op_sel_hi:[1,0,0]
    v_cvt_pk_bf16_f32 v122, v36, v37
    v_lshlrev_b32 v38, 16, v123
    v_and_b32 v39, 0xffff0000, v123
    v_pk_fma_f32 v[38:39], v[38:39], v[28:29], v[30:31] op_sel_hi:[1,0,0]
    v_cvt_pk_bf16_f32 v123, v38, v39
    ds_write_b128 v5, v[120:123] offset:8192
    v_lshlrev_b32 v32, 16, v124
    v_and_b32 v33, 0xffff0000, v124
    v_pk_fma_f32 v[32:33], v[32:33], v[28:29], v[30:31] op_sel_hi:[1,0,0]
    v_cvt_pk_bf16_f32 v124, v32, v33
    v_lshlrev_b32 v34, 16, v125
    v_and_b32 v35, 0xffff0000, v125
    v_pk_fma_f32 v[34:35], v[34:35], v[28:29], v[30:31] op_sel_hi:[1,0,0]
    v_cvt_pk_bf16_f32 v125, v34, v35
    v_lshlrev_b32 v36, 16, v126
    v_and_b32 v37, 0xffff0000, v126
    v_pk_fma_f32 v[36:37], v[36:37], v[28:29], v[30:31] op_sel_hi:[1,0,0]
    v_cvt_pk_bf16_f32 v126, v36, v37
    v_lshlrev_b32 v38, 16, v127
    v_and_b32 v39, 0xffff0000, v127
    v_pk_fma_f32 v[38:39], v[38:39], v[28:29], v[30:31] op_sel_hi:[1,0,0]
    v_cvt_pk_bf16_f32 v127, v38, v39
    ds_write_b128 v5, v[124:127] offset:12288
    v_lshlrev_b32 v32, 16, v128
    v_and_b32 v33, 0xffff0000, v128
    v_pk_fma_f32 v[32:33], v[32:33], v[28:29], v[30:31] op_sel_hi:[1,0,0]
    v_cvt_pk_bf16_f32 v128, v32, v33
    v_lshlrev_b32 v34, 16, v129
    v_and_b32 v35, 0xffff0000, v129
    v_pk_fma_f32 v[34:35], v[34:35], v[28:29], v[30:31] op_sel_hi:[1,0,0]
    v_cvt_pk_bf16_f32 v129, v34, v35
    v_lshlrev_b32 v36, 16, v130
    v_and_b32 v37, 0xffff0000, v130
    v_pk_fma_f32 v[36:37], v[36:37], v[28:29], v[30:31] op_sel_hi:[1,0,0]
    v_cvt_pk_bf16_f32 v130, v36, v37
    v_lshlrev_b32 v38, 16, v131
    v_and_b32 v39, 0xffff0000, v131
    v_pk_fma_f32 v[38:39], v[38:39], v[28:29], v[30:31] op_sel_hi:[1,0,0]
    v_cvt_pk_bf16_f32 v131, v38, v39
    ds_write_b128 v5, v[128:131] offset:16384
    v_lshlrev_b32 v32, 16, v132
    v_and_b32 v33, 0xffff0000, v132
    v_pk_fma_f32 v[32:33], v[32:33], v[28:29], v[30:31] op_sel_hi:[1,0,0]
    v_cvt_pk_bf16_f32 v132, v32, v33
    v_lshlrev_b32 v34, 16, v133
    v_and_b32 v35, 0xffff0000, v133
    v_pk_fma_f32 v[34:35], v[34:35], v[28:29], v[30:31] op_sel_hi:[1,0,0]
    v_cvt_pk_bf16_f32 v133, v34, v35
    v_lshlrev_b32 v36, 16, v134
    v_and_b32 v37, 0xffff0000, v134
    v_pk_fma_f32 v[36:37], v[36:37], v[28:29], v[30:31] op_sel_hi:[1,0,0]
    v_cvt_pk_bf16_f32 v134, v36, v37
    v_lshlrev_b32 v38, 16, v135
    v_and_b32 v39, 0xffff0000, v135
    v_pk_fma_f32 v[38:39], v[38:39], v[28:29], v[30:31] op_sel_hi:[1,0,0]
    v_cvt_pk_bf16_f32 v135, v38, v39
    ds_write_b128 v5, v[132:135] offset:20480
    v_lshlrev_b32 v32, 16, v136
    v_and_b32 v33, 0xffff0000, v136
    v_pk_fma_f32 v[32:33], v[32:33], v[28:29], v[30:31] op_sel_hi:[1,0,0]
    v_cvt_pk_bf16_f32 v136, v32, v33
    v_lshlrev_b32 v34, 16, v137
    v_and_b32 v35, 0xffff0000, v137
    v_pk_fma_f32 v[34:35], v[34:35], v[28:29], v[30:31] op_sel_hi:[1,0,0]
    v_cvt_pk_bf16_f32 v137, v34, v35
    v_lshlrev_b32 v36, 16, v138
    v_and_b32 v37, 0xffff0000, v138
    v_pk_fma_f32 v[36:37], v[36:37], v[28:29], v[30:31] op_sel_hi:[1,0,0]
    v_cvt_pk_bf16_f32 v138, v36, v37
    v_lshlrev_b32 v38, 16, v139
    v_and_b32 v39, 0xffff0000, v139
    v_pk_fma_f32 v[38:39], v[38:39], v[28:29], v[30:31] op_sel_hi:[1,0,0]
    v_cvt_pk_bf16_f32 v139, v38, v39
    ds_write_b128 v5, v[136:139] offset:24576
    s_waitcnt vmcnt(0)
    v_mov_b32 v24, 0
    v_mov_b32 v25, 0
    v_mov_b32 v26, 0
    v_mov_b32 v27, 0
    v_dot2_f32_bf16 v24, v140, s87, v24
    v_dot2_f32_bf16 v26, v140, v140, v26
    v_dot2_f32_bf16 v25, v141, s87, v25
    v_dot2_f32_bf16 v27, v141, v141, v27
    v_dot2_f32_bf16 v24, v142, s87, v24
    v_dot2_f32_bf16 v26, v142, v142, v26
    v_dot2_f32_bf16 v25, v143, s87, v25
    v_dot2_f32_bf16 v27, v143, v143, v27
    v_dot2_f32_bf16 v24, v144, s87, v24
    v_dot2_f32_bf16 v26, v144, v144, v26
    v_dot2_f32_bf16 v25, v145, s87, v25
    v_dot2_f32_bf16 v27, v145, v145, v27
    v_dot2_f32_bf16 v24, v146, s87, v24
    v_dot2_f32_bf16 v26, v146, v146, v26
    v_dot2_f32_bf16 v25, v147, s87, v25
    v_dot2_f32_bf16 v27, v147, v147, v27
    v_dot2_f32_bf16 v24, v148, s87, v24
    v_dot2_f32_bf16 v26, v148, v148, v26
    v_dot2_f32_bf16 v25, v149, s87, v25
    v_dot2_f32_bf16 v27, v149, v149, v27
    v_dot2_f32_bf16 v24, v150, s87, v24
    v_dot2_f32_bf16 v26, v150, v150, v26
    v_dot2_f32_bf16 v25, v151, s87, v25
    v_dot2_f32_bf16 v27, v151, v151, v27
    v_dot2_f32_bf16 v24, v152, s87, v24
    v_dot2_f32_bf16 v26, v152, v152, v26
    v_dot2_f32_bf16 v25, v153, s87, v25
    v_dot2_f32_bf16 v27, v153, v153, v27
    v_dot2_f32_bf16 v24, v154, s87, v24
    v_dot2_f32_bf16 v26, v154, v154, v26
    v_dot2_f32_bf16 v25, v155, s87, v25
    v_dot2_f32_bf16 v27, v155, v155, v27
    v_dot2_f32_bf16 v24, v156, s87, v24
    v_dot2_f32_bf16 v26, v156, v156, v26
    v_dot2_f32_bf16 v25, v157, s87, v25
    v_dot2_f32_bf16 v27, v157, v157, v27
    v_dot2_f32_bf16 v24, v158, s87, v24
    v_dot2_f32_bf16 v26, v158, v158, v26
    v_dot2_f32_bf16 v25, v159, s87, v25
    v_dot2_f32_bf16 v27, v159, v159, v27
    v_dot2_f32_bf16 v24, v160, s87, v24
    v_dot2_f32_bf16 v26, v160, v160, v26
    v_dot2_f32_bf16 v25, v161, s87, v25
    v_dot2_f32_bf16 v27, v161, v161, v27
    v_dot2_f32_bf16 v24, v162, s87, v24
    v_dot2_f32_bf16 v26, v162, v162, v26
    v_dot2_f32_bf16 v25, v163, s87, v25
    v_dot2_f32_bf16 v27, v163, v163, v27
    v_dot2_f32_bf16 v24, v164, s87, v24
    v_dot2_f32_bf16 v26, v164, v164, v26
    v_dot2_f32_bf16 v25, v165, s87, v25
    v_dot2_f32_bf16 v27, v165, v165, v27
    v_dot2_f32_bf16 v24, v166, s87, v24
    v_dot2_f32_bf16 v26, v166, v166, v26
    v_dot2_f32_bf16 v25, v167, s87, v25
    v_dot2_f32_bf16 v27, v167, v167, v27
    s_nop 1
    v_add_f32 v24, v24, v25
    v_add_f32 v26, v26, v27
    s_nop 0
    v_add_f32_dpp v24, v24, v24 quad_perm:[1,0,3,2] row_mask:0xf bank_mask:0xf
    v_add_f32_dpp v26, v26, v26 quad_perm:[1,0,3,2] row_mask:0xf bank_mask:0xf
    s_nop 0
    v_add_f32_dpp v24, v24, v24 quad_perm:[2,3,0,1] row_mask:0xf bank_mask:0xf
    v_add_f32_dpp v26, v26, v26 quad_perm:[2,3,0,1] row_mask:0xf bank_mask:0xf
    s_nop 0
    v_add_f32_dpp v24, v24, v24 row_half_mirror row_mask:0xf bank_mask:0xf
    v_add_f32_dpp v26, v26, v26 row_half_mirror row_mask:0xf bank_mask:0xf
    v_mul_f32 v24, 0x3b124925, v24
    v_mul_f32 v26, 0x3b124925, v26
    v_fma_f32 v26, -v24, v24, v26
    v_max_f32 v26, 0, v26
    v_add_f32 v26, 0x3727c5ac, v26
    v_rsq_f32 v28, v26
    s_nop 0
    v_mul_f32_e64 v30, -v24, v28
    v_lshlrev_b32 v32, 16, v140
    v_and_b32 v33, 0xffff0000, v140
    v_pk_fma_f32 v[32:33], v[32:33], v[28:29], v[30:31] op_sel_hi:[1,0,0]
    v_cvt_pk_bf16_f32 v140, v32, v33
    v_lshlrev_b32 v34, 16, v141
    v_and_b32 v35, 0xffff0000, v141
    v_pk_fma_f32 v[34:35], v[34:35], v[28:29], v[30:31] op_sel_hi:[1,0,0]
    v_cvt_pk_bf16_f32 v141, v34, v35
    v_lshlrev_b32 v36, 16, v142
    v_and_b32 v37, 0xffff0000, v142
    v_pk_fma_f32 v[36:37], v[36:37], v[28:29], v[30:31] op_sel_hi:[1,0,0]
    v_cvt_pk_bf16_f32 v142, v36, v37
    v_lshlrev_b32 v38, 16, v143
    v_and_b32 v39, 0xffff0000, v143
    v_pk_fma_f32 v[38:39], v[38:39], v[28:29], v[30:31] op_sel_hi:[1,0,0]
    v_cvt_pk_bf16_f32 v143, v38, v39
    ds_write_b128 v5, v[140:143] offset:128
    v_lshlrev_b32 v32, 16, v144
    v_and_b32 v33, 0xffff0000, v144
    v_pk_fma_f32 v[32:33], v[32:33], v[28:29], v[30:31] op_sel_hi:[1,0,0]
    v_cvt_pk_bf16_f32 v144, v32, v33
    v_lshlrev_b32 v34, 16, v145
    v_and_b32 v35, 0xffff0000, v145
    v_pk_fma_f32 v[34:35], v[34:35], v[28:29], v[30:31] op_sel_hi:[1,0,0]
    v_cvt_pk_bf16_f32 v145, v34, v35
    v_lshlrev_b32 v36, 16, v146
    v_and_b32 v37, 0xffff0000, v146
    v_pk_fma_f32 v[36:37], v[36:37], v[28:29], v[30:31] op_sel_hi:[1,0,0]
    v_cvt_pk_bf16_f32 v146, v36, v37
    v_lshlrev_b32 v38, 16, v147
    v_and_b32 v39, 0xffff0000, v147
    v_pk_fma_f32 v[38:39], v[38:39], v[28:29], v[30:31] op_sel_hi:[1,0,0]
    v_cvt_pk_bf16_f32 v147, v38, v39
    ds_write_b128 v5, v[144:147] offset:4224
    v_lshlrev_b32 v32, 16, v148
    v_and_b32 v33, 0xffff0000, v148
    v_pk_fma_f32 v[32:33], v[32:33], v[28:29], v[30:31] op_sel_hi:[1,0,0]
    v_cvt_pk_bf16_f32 v148, v32, v33
    v_lshlrev_b32 v34, 16, v149
    v_and_b32 v35, 0xffff0000, v149
    v_pk_fma_f32 v[34:35], v[34:35], v[28:29], v[30:31] op_sel_hi:[1,0,0]
    v_cvt_pk_bf16_f32 v149, v34, v35
    v_lshlrev_b32 v36, 16, v150
    v_and_b32 v37, 0xffff0000, v150
    v_pk_fma_f32 v[36:37], v[36:37], v[28:29], v[30:31] op_sel_hi:[1,0,0]
    v_cvt_pk_bf16_f32 v150, v36, v37
    v_lshlrev_b32 v38, 16, v151
    v_and_b32 v39, 0xffff0000, v151
    v_pk_fma_f32 v[38:39], v[38:39], v[28:29], v[30:31] op_sel_hi:[1,0,0]
    v_cvt_pk_bf16_f32 v151, v38, v39
    ds_write_b128 v5, v[148:151] offset:8320
    v_lshlrev_b32 v32, 16, v152
    v_and_b32 v33, 0xffff0000, v152
    v_pk_fma_f32 v[32:33], v[32:33], v[28:29], v[30:31] op_sel_hi:[1,0,0]
    v_cvt_pk_bf16_f32 v152, v32, v33
    v_lshlrev_b32 v34, 16, v153
    v_and_b32 v35, 0xffff0000, v153
    v_pk_fma_f32 v[34:35], v[34:35], v[28:29], v[30:31] op_sel_hi:[1,0,0]
    v_cvt_pk_bf16_f32 v153, v34, v35
    v_lshlrev_b32 v36, 16, v154
    v_and_b32 v37, 0xffff0000, v154
    v_pk_fma_f32 v[36:37], v[36:37], v[28:29], v[30:31] op_sel_hi:[1,0,0]
    v_cvt_pk_bf16_f32 v154, v36, v37
    v_lshlrev_b32 v38, 16, v155
    v_and_b32 v39, 0xffff0000, v155
    v_pk_fma_f32 v[38:39], v[38:39], v[28:29], v[30:31] op_sel_hi:[1,0,0]
    v_cvt_pk_bf16_f32 v155, v38, v39
    ds_write_b128 v5, v[152:155] offset:12416
    v_lshlrev_b32 v32, 16, v156
    v_and_b32 v33, 0xffff0000, v156
    v_pk_fma_f32 v[32:33], v[32:33], v[28:29], v[30:31] op_sel_hi:[1,0,0]
    v_cvt_pk_bf16_f32 v156, v32, v33
    v_lshlrev_b32 v34, 16, v157
    v_and_b32 v35, 0xffff0000, v157
    v_pk_fma_f32 v[34:35], v[34:35], v[28:29], v[30:31] op_sel_hi:[1,0,0]
    v_cvt_pk_bf16_f32 v157, v34, v35
    v_lshlrev_b32 v36, 16, v158
    v_and_b32 v37, 0xffff0000, v158
    v_pk_fma_f32 v[36:37], v[36:37], v[28:29], v[30:31] op_sel_hi:[1,0,0]
    v_cvt_pk_bf16_f32 v158, v36, v37
    v_lshlrev_b32 v38, 16, v159
    v_and_b32 v39, 0xffff0000, v159
    v_pk_fma_f32 v[38:39], v[38:39], v[28:29], v[30:31] op_sel_hi:[1,0,0]
    v_cvt_pk_bf16_f32 v159, v38, v39
    ds_write_b128 v5, v[156:159] offset:16512
    v_lshlrev_b32 v32, 16, v160
    v_and_b32 v33, 0xffff0000, v160
    v_pk_fma_f32 v[32:33], v[32:33], v[28:29], v[30:31] op_sel_hi:[1,0,0]
    v_cvt_pk_bf16_f32 v160, v32, v33
    v_lshlrev_b32 v34, 16, v161
    v_and_b32 v35, 0xffff0000, v161
    v_pk_fma_f32 v[34:35], v[34:35], v[28:29], v[30:31] op_sel_hi:[1,0,0]
    v_cvt_pk_bf16_f32 v161, v34, v35
    v_lshlrev_b32 v36, 16, v162
    v_and_b32 v37, 0xffff0000, v162
    v_pk_fma_f32 v[36:37], v[36:37], v[28:29], v[30:31] op_sel_hi:[1,0,0]
    v_cvt_pk_bf16_f32 v162, v36, v37
    v_lshlrev_b32 v38, 16, v163
    v_and_b32 v39, 0xffff0000, v163
    v_pk_fma_f32 v[38:39], v[38:39], v[28:29], v[30:31] op_sel_hi:[1,0,0]
    v_cvt_pk_bf16_f32 v163, v38, v39
    ds_write_b128 v5, v[160:163] offset:20608
    v_lshlrev_b32 v32, 16, v164
    v_and_b32 v33, 0xffff0000, v164
    v_pk_fma_f32 v[32:33], v[32:33], v[28:29], v[30:31] op_sel_hi:[1,0,0]
    v_cvt_pk_bf16_f32 v164, v32, v33
    v_lshlrev_b32 v34, 16, v165
    v_and_b32 v35, 0xffff0000, v165
    v_pk_fma_f32 v[34:35], v[34:35], v[28:29], v[30:31] op_sel_hi:[1,0,0]
    v_cvt_pk_bf16_f32 v165, v34, v35
    v_lshlrev_b32 v36, 16, v166
    v_and_b32 v37, 0xffff0000, v166
    v_pk_fma_f32 v[36:37], v[36:37], v[28:29], v[30:31] op_sel_hi:[1,0,0]
    v_cvt_pk_bf16_f32 v166, v36, v37
    v_lshlrev_b32 v38, 16, v167
    v_and_b32 v39, 0xffff0000, v167
    v_pk_fma_f32 v[38:39], v[38:39], v[28:29], v[30:31] op_sel_hi:[1,0,0]
    v_cvt_pk_bf16_f32 v167, v38, v39
    ds_write_b128 v5, v[164:167] offset:24704
    v_lshrrev_b32 v4, 4, v1
    v_and_b32 v2, 15, v1
    v_lshrrev_b32 v6, 2, v2
    v_and_b32 v2, 3, v2
    v_lshrrev_b32 v7, 1, v4
    v_and_b32 v4, 1, v4
    v_lshl_add_u32 v7, v7, 3, v6
    v_lshlrev_b32 v4, 5, v4
    v_lshl_add_u32 v4, v2, 3, v4
    v_lshl_add_u32 v36, v7, 6, v4
    v_lshrrev_b32 v6, 1, v6
    v_xor_b32 v6, s7, v6
    v_lshl_add_u32 v4, v6, 6, v4
    v_lshl_add_u32 v37, v7, 7, v4
    v_mov_b32 v12, 0x3f80
    v_mov_b32 v13, 0
    v_cmp_gt_u32 vcc, 32, v1
    s_nop 1
    v_cndmask_b32 v12, v13, v12, vcc
    v_mov_b32 v14, 0
    v_mov_b32 v15, 0
    v_mov_b32 v21, 0
    v_mov_b32 v22, 0
    v_mov_b32 v23, 0
    v_and_b32 v4, 31, v1
    v_mov_b32 v19, 0
    v_mov_b32 v2, 0x3f803f80
    v_cmp_eq_u32 vcc, 28, v4
    s_nop 1
    v_cndmask_b32 v19, v19, v2, vcc
    v_cmp_le_u32 s[78:79], 28, v4
    s_waitcnt lgkmcnt(0)
    s_mov_b64 exec, 1
    v_mov_b32 v2, 162896
    v_mov_b32 v3, 1
    ds_add_u32 v2, v3
    s_mov_b64 exec, -1
    v_mov_b32 v2, 162896
    s_mov_b32 s69, 0
L_sp_3:
    ds_read_b32 v3, v2
    s_add_u32 s69, s69, 1
    s_waitcnt lgkmcnt(0)
    v_readfirstlane_b32 s68, v3
    s_nop 0
    s_cmp_ge_u32 s68, 8
    s_cbranch_scc1 L_spd_4
    s_cmp_gt_u32 s69, 1048576
    s_cbranch_scc1 L_spd_4
    s_sleep 1
    s_branch L_sp_3
L_spd_4:
    s_cmp_eq_u32 s7, 0
    s_cbranch_scc0 L_noxn_5
    v_mov_b32 v2, 162836
    s_mov_b32 s69, 0
L_sp_6:
    ds_read_b32 v3, v2
    s_add_u32 s69, s69, 1
    s_waitcnt lgkmcnt(0)
    v_readfirstlane_b32 s68, v3
    s_nop 0
    s_cmp_ge_u32 s68, 4
    s_cbranch_scc1 L_spd_7
    s_cmp_gt_u32 s69, 1048576
    s_cbranch_scc1 L_spd_7
    s_sleep 1
    s_branch L_sp_6
L_spd_7:
    s_setprio 3
    ds_read_b128 v[56:59], v8 offset:0
    ds_read_b128 v[60:63], v9 offset:1024
    ds_read_b128 v[64:67], v10 offset:2048
    ds_read_b128 v[68:71], v11 offset:3072
    ds_read_b128 v[72:75], v8 offset:4096
    ds_read_b128 v[76:79], v9 offset:5120
    ds_read_b128 v[80:83], v10 offset:6144
    ds_read_b128 v[84:87], v11 offset:7168
    ds_read_b128 v[88:91], v8 offset:8192
    ds_read_b128 v[92:95], v9 offset:9216
    ds_read_b128 v[96:99], v10 offset:10240
    ds_read_b128 v[100:103], v11 offset:11264
    ds_read_b128 v[104:107], v8 offset:12288
    ds_read_b128 v[108:111], v9 offset:13312
    ds_read_b128 v[112:115], v10 offset:14336
    ds_read_b128 v[116:119], v11 offset:15360
    ds_read_b128 v[120:123], v8 offset:16384
    ds_read_b128 v[124:127], v9 offset:17408
    ds_read_b128 v[128:131], v10 offset:18432
    ds_read_b128 v[132:135], v11 offset:19456
    ds_read_b128 v[136:139], v8 offset:20480
    ds_read_b128 v[140:143], v9 offset:21504
    ds_read_b128 v[144:147], v10 offset:22528
    ds_read_b128 v[148:151], v11 offset:23552
    ds_read_b128 v[152:155], v8 offset:24576
    ds_read_b128 v[156:159], v9 offset:25600
    ds_read_b128 v[160:163], v10 offset:26624
    ds_read_b128 v[164:167], v11 offset:27648
    s_waitcnt lgkmcnt(0)
    s_mov_b64 exec, 1
    v_mov_b32 v2, 162864
    v_mov_b32 v3, 1
    ds_add_u32 v2, v3
    s_mov_b64 exec, -1
L_noxn_5:
    s_setprio 0
    v_mov_b32 v8, v36
    v_mov_b32 v9, v37
    v_lshlrev_b32 v10, 4, v1
    s_cmp_eq_u32 s7, 0
    s_cbranch_scc0 L_cp1_8
    v_add_u32 v11, 114688, v8
    s_setprio 2
    ds_read_b64_tr_b16 v[24:25], v11 offset:0
    ds_read_b64_tr_b16 v[26:27], v11 offset:256
    ds_read_b64_tr_b16 v[28:29], v11 offset:1024
    ds_read_b64_tr_b16 v[30:31], v11 offset:1280
    ds_read_b64_tr_b16 v[32:33], v11 offset:2048
    ds_read_b64_tr_b16 v[34:35], v11 offset:2304
    ds_read_b64_tr_b16 v[36:37], v11 offset:3072
    ds_read_b64_tr_b16 v[38:39], v11 offset:3328
    s_waitcnt lgkmcnt(6)
    v_mfma_f32_32x32x16_bf16 v[40:55], v[24:27], v[56:59], 0
    ds_read_b64_tr_b16 v[24:25], v11 offset:4096
    ds_read_b64_tr_b16 v[26:27], v11 offset:4352
    s_waitcnt lgkmcnt(6)
    v_mfma_f32_32x32x16_bf16 v[40:55], v[28:31], v[60:63], v[40:55]
    ds_read_b64_tr_b16 v[28:29], v11 offset:5120
    ds_read_b64_tr_b16 v[30:31], v11 offset:5376
    s_waitcnt lgkmcnt(6)
    v_mfma_f32_32x32x16_bf16 v[40:55], v[32:35], v[64:67], v[40:55]
    ds_read_b64_tr_b16 v[32:33], v11 offset:6144
    ds_read_b64_tr_b16 v[34:35], v11 offset:6400
    s_waitcnt lgkmcnt(6)
    v_mfma_f32_32x32x16_bf16 v[40:55], v[36:39], v[68:71], v[40:55]
    ds_read_b64_tr_b16 v[36:37], v11 offset:7168
    ds_read_b64_tr_b16 v[38:39], v11 offset:7424
    s_waitcnt lgkmcnt(6)
    v_mfma_f32_32x32x16_bf16 v[40:55], v[24:27], v[72:75], v[40:55]
    ds_read_b64_tr_b16 v[24:25], v11 offset:8192
    ds_read_b64_tr_b16 v[26:27], v11 offset:8448
    s_waitcnt lgkmcnt(6)
    v_mfma_f32_32x32x16_bf16 v[40:55], v[28:31], v[76:79], v[40:55]
    ds_read_b64_tr_b16 v[28:29], v11 offset:9216
    ds_read_b64_tr_b16 v[30:31], v11 offset:9472
    s_waitcnt lgkmcnt(6)
    v_mfma_f32_32x32x16_bf16 v[40:55], v[32:35], v[80:83], v[40:55]
    ds_read_b64_tr_b16 v[32:33], v11 offset:10240
    ds_read_b64_tr_b16 v[34:35], v11 offset:10496
    s_waitcnt lgkmcnt(6)
    v_mfma_f32_32x32x16_bf16 v[40:55], v[36:39], v[84:87], v[40:55]
    ds_read_b64_tr_b16 v[36:37], v11 offset:11264
    ds_read_b64_tr_b16 v[38:39], v11 offset:11520
    s_waitcnt lgkmcnt(6)
    v_mfma_f32_32x32x16_bf16 v[40:55], v[24:27], v[88:91], v[40:55]
    ds_read_b64_tr_b16 v[24:25], v11 offset:12288
    ds_read_b64_tr_b16 v[26:27], v11 offset:12544
    s_waitcnt lgkmcnt(6)
    v_mfma_f32_32x32x16_bf16 v[40:55], v[28:31], v[92:95], v[40:55]
    ds_read_b64_tr_b16 v[28:29], v11 offset:13312
    ds_read_b64_tr_b16 v[30:31], v11 offset:13568
    s_waitcnt lgkmcnt(6)
    v_mfma_f32_32x32x16_bf16 v[40:55], v[32:35], v[96:99], v[40:55]
    ds_read_b64_tr_b16 v[32:33], v11 offset:14336
    ds_read_b64_tr_b16 v[34:35], v11 offset:14592
    s_waitcnt lgkmcnt(6)
    v_mfma_f32_32x32x16_bf16 v[40:55], v[36:39], v[100:103], v[40:55]
    ds_read_b64_tr_b16 v[36:37], v11 offset:15360
    ds_read_b64_tr_b16 v[38:39], v11 offset:15616
    s_waitcnt lgkmcnt(6)
    v_mfma_f32_32x32x16_bf16 v[40:55], v[24:27], v[104:107], v[40:55]
    ds_read_b64_tr_b16 v[24:25], v11 offset:16384
    ds_read_b64_tr_b16 v[26:27], v11 offset:16640
    s_waitcnt lgkmcnt(6)
    v_mfma_f32_32x32x16_bf16 v[40:55], v[28:31], v[108:111], v[40:55]
    ds_read_b64_tr_b16 v[28:29], v11 offset:17408
    ds_read_b64_tr_b16 v[30:31], v11 offset:17664
    s_waitcnt lgkmcnt(6)
    v_mfma_f32_32x32x16_bf16 v[40:55], v[32:35], v[112:115], v[40:55]
    ds_read_b64_tr_b16 v[32:33], v11 offset:18432
    ds_read_b64_tr_b16 v[34:35], v11 offset:18688
    s_waitcnt lgkmcnt(6)
    v_mfma_f32_32x32x16_bf16 v[40:55], v[36:39], v[116:119], v[40:55]
    ds_read_b64_tr_b16 v[36:37], v11 offset:19456
    ds_read_b64_tr_b16 v[38:39], v11 offset:19712
    s_waitcnt lgkmcnt(6)
    v_mfma_f32_32x32x16_bf16 v[40:55], v[24:27], v[120:123], v[40:55]
    ds_read_b64_tr_b16 v[24:25], v11 offset:20480
    ds_read_b64_tr_b16 v[26:27], v11 offset:20736
    s_waitcnt lgkmcnt(6)
    v_mfma_f32_32x32x16_bf16 v[40:55], v[28:31], v[124:127], v[40:55]
    ds_read_b64_tr_b16 v[28:29], v11 offset:21504
    ds_read_b64_tr_b16 v[30:31], v11 offset:21760
    s_waitcnt lgkmcnt(6)
    v_mfma_f32_32x32x16_bf16 v[40:55], v[32:35], v[128:131], v[40:55]
    ds_read_b64_tr_b16 v[32:33], v11 offset:22528
    ds_read_b64_tr_b16 v[34:35], v11 offset:22784
    s_waitcnt lgkmcnt(6)
    v_mfma_f32_32x32x16_bf16 v[40:55], v[36:39], v[132:135], v[40:55]
    ds_read_b64_tr_b16 v[36:37], v11 offset:23552
    ds_read_b64_tr_b16 v[38:39], v11 offset:23808
    s_waitcnt lgkmcnt(6)
    v_mfma_f32_32x32x16_bf16 v[40:55], v[24:27], v[136:139], v[40:55]
    ds_read_b64_tr_b16 v[24:25], v11 offset:24576
    ds_read_b64_tr_b16 v[26:27], v11 offset:24832
    s_waitcnt lgkmcnt(6)
    v_mfma_f32_32x32x16_bf16 v[40:55], v[28:31], v[140:143], v[40:55]
    ds_read_b64_tr_b16 v[28:29], v11 offset:25600
    ds_read_b64_tr_b16 v[30:31], v11 offset:25856
    s_waitcnt lgkmcnt(6)
    v_mfma_f32_32x32x16_bf16 v[40:55], v[32:35], v[144:147], v[40:55]
    ds_read_b64_tr_b16 v[32:33], v11 offset:26624
    ds_read_b64_tr_b16 v[34:35], v11 offset:26880
    s_waitcnt lgkmcnt(6)
    v_mfma_f32_32x32x16_bf16 v[40:55], v[36:39], v[148:151], v[40:55]
    ds_read_b64_tr_b16 v[36:37], v11 offset:27648
    ds_read_b64_tr_b16 v[38:39], v11 offset:27904
    s_waitcnt lgkmcnt(6)
    v_mfma_f32_32x32x16_bf16 v[40:55], v[24:27], v[152:155], v[40:55]
    s_waitcnt lgkmcnt(4)
    v_mfma_f32_32x32x16_bf16 v[40:55], v[28:31], v[156:159], v[40:55]
    s_waitcnt lgkmcnt(2)
    v_mfma_f32_32x32x16_bf16 v[40:55], v[32:35], v[160:163], v[40:55]
    s_waitcnt lgkmcnt(0)
    v_mfma_f32_32x32x16_bf16 v[40:55], v[36:39], v[164:167], v[40:55]
    s_setprio 0
    s_mov_b64 exec, 1
    v_mov_b32 v2, 162856
    v_mov_b32 v3, 1
    ds_add_u32 v2, v3
    s_mov_b64 exec, -1
    s_mov_b32 exec_lo, 0
    s_nop 4
    v_mov_b32 v52, 0
    v_mov_b32 v53, 0
    v_mov_b32 v54, 0
    v_mov_b32 v55, 0
    s_mov_b64 exec, -1
    v_mul_f32 v2, v40, v40
    v_mul_f32 v3, v41, v41
    v_fmac_f32 v2, v42, v42
    v_fmac_f32 v3, v43, v43
    v_fmac_f32 v2, v44, v44
    v_fmac_f32 v3, v45, v45
    v_fmac_f32 v2, v46, v46
    v_fmac_f32 v3, v47, v47
    v_fmac_f32 v2, v48, v48
    v_fmac_f32 v3, v49, v49
    v_fmac_f32 v2, v50, v50
    v_fmac_f32 v3, v51, v51
    v_fmac_f32 v2, v52, v52
    v_fmac_f32 v3, v53, v53
    v_fmac_f32 v2, v54, v54
    v_fmac_f32 v3, v55, v55
    v_add_f32 v2, v2, v3
    v_mov_b32 v3, v2
    s_nop 1
    v_permlane32_swap_b32 v3, v2
    v_add_f32 v2, v2, v3
    s_nop 1
    v_max_f32_dpp v2, v2, v2 quad_perm:[1,0,3,2] row_mask:0xf bank_mask:0xf
    s_nop 1
    v_max_f32_dpp v2, v2, v2 quad_perm:[2,3,0,1] row_mask:0xf bank_mask:0xf
    s_nop 1
    v_max_f32_dpp v2, v2, v2 row_half_mirror row_mask:0xf bank_mask:0xf
    s_nop 1
    v_max_f32_dpp v2, v2, v2 row_mirror row_mask:0xf bank_mask:0xf
    v_mov_b32 v3, 162880
    s_mov_b64 exec, 0x10001
    ds_max_u32 v3, v2
    s_mov_b64 exec, -1
    v_cvt_pk_bf16_f32 v40, v40, v41
    v_cvt_pk_bf16_f32 v41, v42, v43
    v_cvt_pk_bf16_f32 v42, v44, v45
    v_cvt_pk_bf16_f32 v43, v46, v47
    v_cvt_pk_bf16_f32 v44, v48, v49
    v_cvt_pk_bf16_f32 v45, v50, v51
    v_cvt_pk_bf16_f32 v46, v52, v53
    v_cvt_pk_bf16_f32 v47, v54, v55
    s_mov_b32 exec_lo, 0
    v_mov_b32 v46, 0x3f803f80
    s_mov_b64 exec, -1
    s_lshl_b32 s68, s4, 18
    s_lshl_b32 s69, s5, 14
    s_add_u32 s68, s68, s69
    s_lshl_b32 s69, s6, 12
    s_add_u32 s68, s68, s69
    s_add_u32 s68, s68, 1048576
    buffer_store_dwordx4 v[40:43], v10, s[40:43], s68 offen sc1
    buffer_store_dwordx4 v[44:47], v10, s[40:43], s68 offen offset:1024 sc1
    v_mov_b32 v2, 162852
    s_mov_b32 s69, 0
L_sp_10:
    ds_read_b32 v3, v2
    s_add_u32 s69, s69, 1
    s_waitcnt lgkmcnt(0)
    v_readfirstlane_b32 s68, v3
    s_nop 0
    s_cmp_ge_u32 s68, 4
    s_cbranch_scc1 L_spd_11
    s_cmp_gt_u32 s69, 1048576
    s_cbranch_scc1 L_spd_11
    s_sleep 1
    s_branch L_sp_10
L_spd_11:
    s_waitcnt vmcnt(0)
    s_mov_b64 exec, 1
    v_mov_b32 v2, 162816
    v_mov_b32 v3, 1
    ds_add_rtn_u32 v2, v2, v3
    s_waitcnt lgkmcnt(0)
    v_readfirstlane_b32 s68, v2
    s_nop 0
    s_cmp_eq_u32 s68, 7
    s_cbranch_scc0 L_pub_12
    s_lshl_b32 s68, s4, 4
    s_add_u32 s68, s68, s5
    s_lshl_b32 s68, s68, 7
    s_add_u32 s68, s68, 0
    v_mov_b32 v4, s68
    v_mov_b32 v2, s44
    v_mov_b32 v3, s45
    buffer_store_dwordx2 v[2:3], v4, s[40:43], 0 offen sc1
L_pub_12:
    s_mov_b64 exec, -1
    v_add_u32 v11, 86016, v8
    s_setprio 3
    ds_read_b64_tr_b16 v[24:25], v11 offset:0
    ds_read_b64_tr_b16 v[26:27], v11 offset:256
    ds_read_b64_tr_b16 v[28:29], v11 offset:1024
    ds_read_b64_tr_b16 v[30:31], v11 offset:1280
    ds_read_b64_tr_b16 v[32:33], v11 offset:2048
    ds_read_b64_tr_b16 v[34:35], v11 offset:2304
    ds_read_b64_tr_b16 v[36:37], v11 offset:3072
    ds_read_b64_tr_b16 v[38:39], v11 offset:3328
    s_waitcnt lgkmcnt(6)
    v_mfma_f32_32x32x16_bf16 v[40:55], v[24:27], v[56:59], 0
    ds_read_b64_tr_b16 v[24:25], v11 offset:4096
    ds_read_b64_tr_b16 v[26:27], v11 offset:4352
    s_waitcnt lgkmcnt(6)
    v_mfma_f32_32x32x16_bf16 v[40:55], v[28:31], v[60:63], v[40:55]
    ds_read_b64_tr_b16 v[28:29], v11 offset:5120
    ds_read_b64_tr_b16 v[30:31], v11 offset:5376
    s_waitcnt lgkmcnt(6)
    v_mfma_f32_32x32x16_bf16 v[40:55], v[32:35], v[64:67], v[40:55]
    ds_read_b64_tr_b16 v[32:33], v11 offset:6144
    ds_read_b64_tr_b16 v[34:35], v11 offset:6400
    s_waitcnt lgkmcnt(6)
    v_mfma_f32_32x32x16_bf16 v[40:55], v[36:39], v[68:71], v[40:55]
    ds_read_b64_tr_b16 v[36:37], v11 offset:7168
    ds_read_b64_tr_b16 v[38:39], v11 offset:7424
    s_waitcnt lgkmcnt(6)
    v_mfma_f32_32x32x16_bf16 v[40:55], v[24:27], v[72:75], v[40:55]
    ds_read_b64_tr_b16 v[24:25], v11 offset:8192
    ds_read_b64_tr_b16 v[26:27], v11 offset:8448
    s_waitcnt lgkmcnt(6)
    v_mfma_f32_32x32x16_bf16 v[40:55], v[28:31], v[76:79], v[40:55]
    ds_read_b64_tr_b16 v[28:29], v11 offset:9216
    ds_read_b64_tr_b16 v[30:31], v11 offset:9472
    s_waitcnt lgkmcnt(6)
    v_mfma_f32_32x32x16_bf16 v[40:55], v[32:35], v[80:83], v[40:55]
    ds_read_b64_tr_b16 v[32:33], v11 offset:10240
    ds_read_b64_tr_b16 v[34:35], v11 offset:10496
    s_waitcnt lgkmcnt(6)
    v_mfma_f32_32x32x16_bf16 v[40:55], v[36:39], v[84:87], v[40:55]
    ds_read_b64_tr_b16 v[36:37], v11 offset:11264
    ds_read_b64_tr_b16 v[38:39], v11 offset:11520
    s_waitcnt lgkmcnt(6)
    v_mfma_f32_32x32x16_bf16 v[40:55], v[24:27], v[88:91], v[40:55]
    ds_read_b64_tr_b16 v[24:25], v11 offset:12288
    ds_read_b64_tr_b16 v[26:27], v11 offset:12544
    s_waitcnt lgkmcnt(6)
    v_mfma_f32_32x32x16_bf16 v[40:55], v[28:31], v[92:95], v[40:55]
    ds_read_b64_tr_b16 v[28:29], v11 offset:13312
    ds_read_b64_tr_b16 v[30:31], v11 offset:13568
    s_waitcnt lgkmcnt(6)
    v_mfma_f32_32x32x16_bf16 v[40:55], v[32:35], v[96:99], v[40:55]
    ds_read_b64_tr_b16 v[32:33], v11 offset:14336
    ds_read_b64_tr_b16 v[34:35], v11 offset:14592
    s_waitcnt lgkmcnt(6)
    v_mfma_f32_32x32x16_bf16 v[40:55], v[36:39], v[100:103], v[40:55]
    ds_read_b64_tr_b16 v[36:37], v11 offset:15360
    ds_read_b64_tr_b16 v[38:39], v11 offset:15616
    s_waitcnt lgkmcnt(6)
    v_mfma_f32_32x32x16_bf16 v[40:55], v[24:27], v[104:107], v[40:55]
    ds_read_b64_tr_b16 v[24:25], v11 offset:16384
    ds_read_b64_tr_b16 v[26:27], v11 offset:16640
    s_waitcnt lgkmcnt(6)
    v_mfma_f32_32x32x16_bf16 v[40:55], v[28:31], v[108:111], v[40:55]
    ds_read_b64_tr_b16 v[28:29], v11 offset:17408
    ds_read_b64_tr_b16 v[30:31], v11 offset:17664
    s_waitcnt lgkmcnt(6)
    v_mfma_f32_32x32x16_bf16 v[40:55], v[32:35], v[112:115], v[40:55]
    ds_read_b64_tr_b16 v[32:33], v11 offset:18432
    ds_read_b64_tr_b16 v[34:35], v11 offset:18688
    s_waitcnt lgkmcnt(6)
    v_mfma_f32_32x32x16_bf16 v[40:55], v[36:39], v[116:119], v[40:55]
    ds_read_b64_tr_b16 v[36:37], v11 offset:19456
    ds_read_b64_tr_b16 v[38:39], v11 offset:19712
    s_waitcnt lgkmcnt(6)
    v_mfma_f32_32x32x16_bf16 v[40:55], v[24:27], v[120:123], v[40:55]
    ds_read_b64_tr_b16 v[24:25], v11 offset:20480
    ds_read_b64_tr_b16 v[26:27], v11 offset:20736
    s_waitcnt lgkmcnt(6)
    v_mfma_f32_32x32x16_bf16 v[40:55], v[28:31], v[124:127], v[40:55]
    ds_read_b64_tr_b16 v[28:29], v11 offset:21504
    ds_read_b64_tr_b16 v[30:31], v11 offset:21760
    s_waitcnt lgkmcnt(6)
    v_mfma_f32_32x32x16_bf16 v[40:55], v[32:35], v[128:131], v[40:55]
    ds_read_b64_tr_b16 v[32:33], v11 offset:22528
    ds_read_b64_tr_b16 v[34:35], v11 offset:22784
    s_waitcnt lgkmcnt(6)
    v_mfma_f32_32x32x16_bf16 v[40:55], v[36:39], v[132:135], v[40:55]
    ds_read_b64_tr_b16 v[36:37], v11 offset:23552
    ds_read_b64_tr_b16 v[38:39], v11 offset:23808
    s_waitcnt lgkmcnt(6)
    v_mfma_f32_32x32x16_bf16 v[40:55], v[24:27], v[136:139], v[40:55]
    ds_read_b64_tr_b16 v[24:25], v11 offset:24576
    ds_read_b64_tr_b16 v[26:27], v11 offset:24832
    s_waitcnt lgkmcnt(6)
    v_mfma_f32_32x32x16_bf16 v[40:55], v[28:31], v[140:143], v[40:55]
    ds_read_b64_tr_b16 v[28:29], v11 offset:25600
    ds_read_b64_tr_b16 v[30:31], v11 offset:25856
    s_waitcnt lgkmcnt(6)
    v_mfma_f32_32x32x16_bf16 v[40:55], v[32:35], v[144:147], v[40:55]
    ds_read_b64_tr_b16 v[32:33], v11 offset:26624
    ds_read_b64_tr_b16 v[34:35], v11 offset:26880
    s_waitcnt lgkmcnt(6)
    v_mfma_f32_32x32x16_bf16 v[40:55], v[36:39], v[148:151], v[40:55]
    ds_read_b64_tr_b16 v[36:37], v11 offset:27648
    ds_read_b64_tr_b16 v[38:39], v11 offset:27904
    s_waitcnt lgkmcnt(6)
    v_mfma_f32_32x32x16_bf16 v[40:55], v[24:27], v[152:155], v[40:55]
    s_waitcnt lgkmcnt(4)
    v_mfma_f32_32x32x16_bf16 v[40:55], v[28:31], v[156:159], v[40:55]
    s_waitcnt lgkmcnt(2)
    v_mfma_f32_32x32x16_bf16 v[40:55], v[32:35], v[160:163], v[40:55]
    s_waitcnt lgkmcnt(0)
    v_mfma_f32_32x32x16_bf16 v[40:55], v[36:39], v[164:167], v[40:55]
    s_setprio 0
    s_mov_b64 exec, 1
    v_mov_b32 v2, 162916
    v_mov_b32 v3, 1
    ds_add_u32 v2, v3
    s_mov_b64 exec, -1
    s_mov_b32 s68, 0x3e8b97f6
    s_nop 4
    v_mul_f32 v40, s68, v40
    v_mul_f32 v41, s68, v41
    v_mul_f32 v42, s68, v42
    v_mul_f32 v43, s68, v43
    v_mul_f32 v44, s68, v44
    v_mul_f32 v45, s68, v45
    v_mul_f32 v46, s68, v46
    v_mul_f32 v47, s68, v47
    v_mul_f32 v48, s68, v48
    v_mul_f32 v49, s68, v49
    v_mul_f32 v50, s68, v50
    v_mul_f32 v51, s68, v51
    v_mul_f32 v52, s68, v52
    v_mul_f32 v53, s68, v53
    v_mul_f32 v54, s68, v54
    v_mul_f32 v55, s68, v55
    s_mov_b32 exec_lo, 0
    v_mov_b32 v52, 0
    v_mov_b32 v53, 0
    v_mov_b32 v54, 0
    v_mov_b32 v55, 0
    s_mov_b64 exec, -1
    v_mul_f32 v4, v40, v40
    v_mul_f32 v5, v41, v41
    v_fmac_f32 v4, v42, v42
    v_fmac_f32 v5, v43, v43
    v_fmac_f32 v4, v44, v44
    v_fmac_f32 v5, v45, v45
    v_fmac_f32 v4, v46, v46
    v_fmac_f32 v5, v47, v47
    v_fmac_f32 v4, v48, v48
    v_fmac_f32 v5, v49, v49
    v_fmac_f32 v4, v50, v50
    v_fmac_f32 v5, v51, v51
    v_fmac_f32 v4, v52, v52
    v_fmac_f32 v5, v53, v53
    v_fmac_f32 v4, v54, v54
    v_fmac_f32 v5, v55, v55
    v_add_f32 v4, v4, v5
    v_mov_b32 v5, v4
    s_nop 1
    v_permlane32_swap_b32 v5, v4
    v_add_f32 v4, v4, v5
    v_cvt_pk_bf16_f32 v40, v40, v41
    v_cvt_pk_bf16_f32 v41, v42, v43
    v_cvt_pk_bf16_f32 v42, v44, v45
    v_cvt_pk_bf16_f32 v43, v46, v47
    v_cvt_pk_bf16_f32 v44, v48, v49
    v_cvt_pk_bf16_f32 v45, v50, v51
    v_cvt_pk_bf16_f32 v46, v52, v53
    v_cvt_pk_bf16_f32 v47, v54, v55
    v_mov_b32 v2, 162860
    s_mov_b32 s69, 0
L_sp_13:
    ds_read_b32 v3, v2
    s_add_u32 s69, s69, 1
    s_waitcnt lgkmcnt(0)
    v_readfirstlane_b32 s68, v3
    s_nop 0
    s_cmp_ge_u32 s68, 4
    s_cbranch_scc1 L_spd_14
    s_cmp_gt_u32 s69, 1048576
    s_cbranch_scc1 L_spd_14
    s_sleep 1
    s_branch L_sp_13
L_spd_14:
    s_lshl_b32 s68, s6, 11
    s_add_u32 s68, s68, 143360
    v_add_u32 v2, s68, v10
    ds_write_b128 v2, v[40:43]
    ds_write_b128 v2, v[44:47] offset:1024
    v_and_b32 v3, 31, v1
    v_lshlrev_b32 v3, 2, v3
    s_lshl_b32 s68, s6, 7
    s_add_u32 s68, s68, 159744
    v_add_u32 v3, s68, v3
    ds_write_b32 v3, v4
    s_mov_b64 exec, 1
    v_mov_b32 v2, 162872
    v_mov_b32 v3, 1
    ds_add_u32 v2, v3
    s_mov_b64 exec, -1
    s_branch L_p1done_9
L_cp1_8:
    v_lshrrev_b32 v2, 2, v1
    v_and_b32 v3, 3, v1
    v_lshlrev_b32 v3, 4, v3
    v_mul_u32_u24 v6, 2688, v2
    v_add_u32 v6, v6, v3
    v_lshrrev_b32 v2, 3, v1
    v_bfe_u32 v3, v1, 4, 1
    v_lshlrev_b32 v3, 2, v3
    v_and_b32 v7, 7, v1
    v_xor_b32 v3, v3, v7
    v_lshlrev_b32 v3, 4, v3
    v_mul_u32_u24 v7, 3584, v2
    v_add_u32 v7, v7, v3
    s_setprio 3
    v_mov_b32 v2, 162864
    s_mov_b32 s69, 0
L_sp_15:
    ds_read_b32 v3, v2
    s_add_u32 s69, s69, 1
    s_waitcnt lgkmcnt(0)
    v_readfirstlane_b32 s68, v3
    s_nop 0
    s_cmp_ge_u32 s68, 8
    s_cbranch_scc1 L_spd_16
    s_cmp_gt_u32 s69, 1048576
    s_cbranch_scc1 L_spd_16
    s_nop 0
    s_branch L_sp_15
L_spd_16:
    s_mul_i32 s80, s6, 43008
    s_mul_i32 s81, s4, 56
    s_add_u32 s80, s80, s81
    s_lshl_b32 s81, s6, 10
    s_add_u32 m0, s81, 86016
    s_nop 0
    buffer_load_dwordx4 v6, s[12:15], s80 offen lds
    s_add_u32 m0, m0, 4096
    s_add_u32 s80, s80, 172032
    buffer_load_dwordx4 v6, s[12:15], s80 offen lds
    s_add_u32 m0, m0, 4096
    s_add_u32 s80, s80, 172032
    buffer_load_dwordx4 v6, s[12:15], s80 offen lds
    s_add_u32 m0, m0, 4096
    s_add_u32 s80, s80, 172032
    buffer_load_dwordx4 v6, s[12:15], s80 offen lds
    s_add_u32 m0, m0, 4096
    s_add_u32 s80, s80, 172032
    buffer_load_dwordx4 v6, s[12:15], s80 offen lds
    s_add_u32 m0, m0, 4096
    s_add_u32 s80, s80, 172032
    buffer_load_dwordx4 v6, s[12:15], s80 offen lds
    s_add_u32 m0, m0, 4096
    s_add_u32 s80, s80, 172032
    buffer_load_dwordx4 v6, s[12:15], s80 offen lds
    s_mul_i32 s80, s6, 28672
    s_lshl_b32 s82, s72, 6
    s_lshl_b32 s81, s6, 10
    s_add_u32 m0, s81, 28672
    s_add_u32 s80, s80, s82
    buffer_load_dwordx4 v7, s[20:23], s80 offen lds
    s_add_u32 m0, m0, 4096
    s_add_u32 s80, s80, 114688
    buffer_load_dwordx4 v7, s[20:23], s80 offen lds
    s_add_u32 m0, m0, 4096
    s_add_u32 s80, s80, 114688
    buffer_load_dwordx4 v7, s[20:23], s80 offen lds
    s_add_u32 m0, m0, 4096
    s_add_u32 s80, s80, 114688
    buffer_load_dwordx4 v7, s[20:23], s80 offen lds
    s_add_u32 m0, m0, 4096
    s_add_u32 s80, s80, 114688
    buffer_load_dwordx4 v7, s[20:23], s80 offen lds
    s_add_u32 m0, m0, 4096
    s_add_u32 s80, s80, 114688
    buffer_load_dwordx4 v7, s[20:23], s80 offen lds
    s_add_u32 m0, m0, 4096
    s_add_u32 s80, s80, 114688
    buffer_load_dwordx4 v7, s[20:23], s80 offen lds
    s_add_u32 m0, m0, 4096
    s_add_u32 s80, s80, 114688
    buffer_load_dwordx4 v7, s[20:23], s80 offen lds
    s_add_u32 m0, m0, 4096
    s_add_u32 s80, s80, 114688
    buffer_load_dwordx4 v7, s[20:23], s80 offen lds
    s_add_u32 m0, m0, 4096
    s_add_u32 s80, s80, 114688
    buffer_load_dwordx4 v7, s[20:23], s80 offen lds
    s_add_u32 m0, m0, 4096
    s_add_u32 s80, s80, 114688
    buffer_load_dwordx4 v7, s[20:23], s80 offen lds
    s_add_u32 m0, m0, 4096
    s_add_u32 s80, s80, 114688
    buffer_load_dwordx4 v7, s[20:23], s80 offen lds
    s_add_u32 m0, m0, 4096
    s_add_u32 s80, s80, 114688
    buffer_load_dwordx4 v7, s[20:23], s80 offen lds
    s_add_u32 m0, m0, 4096
    s_add_u32 s80, s80, 114688
    buffer_load_dwordx4 v7, s[20:23], s80 offen lds
    s_waitcnt vmcnt(14)
    s_mov_b64 exec, 1
    v_mov_b32 v2, 162852
    v_mov_b32 v3, 1
    ds_add_u32 v2, v3
    s_mov_b64 exec, -1
    s_waitcnt vmcnt(0)
    s_mov_b64 exec, 1
    v_mov_b32 v2, 162844
    v_mov_b32 v3, 1
    ds_add_u32 v2, v3
    s_mov_b64 exec, -1
    s_cmp_eq_u32 s6, 0
    s_cbranch_scc1 L_kvpoll_17
    s_sub_u32 s79, s6, 1
    s_cmp_eq_u32 s46, 1
    s_cbranch_scc0 L_19
    v_lshrrev_b32 v2, 3, v1
    v_bfe_u32 v3, v1, 4, 1
    v_lshlrev_b32 v3, 2, v3
    v_and_b32 v7, 7, v1
    v_xor_b32 v3, v3, v7
    v_lshlrev_b32 v3, 4, v3
    v_mul_u32_u24 v6, 3584, v2
    v_add_u32 v6, v6, v3
    v_mov_b32 v2, 162856
    s_mov_b32 s69, 0
L_sp_21:
    ds_read_b32 v3, v2
    s_add_u32 s69, s69, 1
    s_waitcnt lgkmcnt(0)
    v_readfirstlane_b32 s68, v3
    s_nop 0
    s_cmp_ge_u32 s68, 4
    s_cbranch_scc1 L_spd_22
    s_cmp_gt_u32 s69, 1048576
    s_cbranch_scc1 L_spd_22
    s_sleep 1
    s_branch L_sp_21
L_spd_22:
    v_mov_b32 v2, 162916
    s_mov_b32 s69, 0
L_sp_23:
    ds_read_b32 v3, v2
    s_add_u32 s69, s69, 1
    s_waitcnt lgkmcnt(0)
    v_readfirstlane_b32 s68, v3
    s_nop 0
    s_cmp_ge_u32 s68, 4
    s_cbranch_scc1 L_spd_24
    s_cmp_gt_u32 s69, 1048576
    s_cbranch_scc1 L_spd_24
    s_sleep 1
    s_branch L_sp_23
L_spd_24:
    s_mul_i32 s80, s79, 28672
    s_lshl_b32 s82, s73, 6
    s_lshl_b32 s81, s79, 10
    s_add_u32 m0, s81, 86016
    s_add_u32 s80, s80, s82
    buffer_load_dwordx4 v6, s[20:23], s80 offen lds
    s_add_u32 m0, m0, 3072
    s_add_u32 s80, s80, 86016
    buffer_load_dwordx4 v6, s[20:23], s80 offen lds
    s_add_u32 m0, m0, 3072
    s_add_u32 s80, s80, 86016
    buffer_load_dwordx4 v6, s[20:23], s80 offen lds
    s_add_u32 m0, m0, 3072
    s_add_u32 s80, s80, 86016
    buffer_load_dwordx4 v6, s[20:23], s80 offen lds
    s_add_u32 m0, m0, 3072
    s_add_u32 s80, s80, 86016
    buffer_load_dwordx4 v6, s[20:23], s80 offen lds
    s_add_u32 m0, m0, 3072
    s_add_u32 s80, s80, 86016
    buffer_load_dwordx4 v6, s[20:23], s80 offen lds
    s_add_u32 m0, m0, 3072
    s_add_u32 s80, s80, 86016
    buffer_load_dwordx4 v6, s[20:23], s80 offen lds
    s_add_u32 m0, m0, 3072
    s_add_u32 s80, s80, 86016
    buffer_load_dwordx4 v6, s[20:23], s80 offen lds
    s_add_u32 m0, m0, 3072
    s_add_u32 s80, s80, 86016
    buffer_load_dwordx4 v6, s[20:23], s80 offen lds
    s_add_u32 m0, m0, 3072
    s_add_u32 s80, s80, 86016
    buffer_load_dwordx4 v6, s[20:23], s80 offen lds
    s_add_u32 m0, m0, 3072
    s_add_u32 s80, s80, 86016
    buffer_load_dwordx4 v6, s[20:23], s80 offen lds
    s_add_u32 m0, m0, 3072
    s_add_u32 s80, s80, 86016
    buffer_load_dwordx4 v6, s[20:23], s80 offen lds
    s_add_u32 m0, m0, 3072
    s_add_u32 s80, s80, 86016
    buffer_load_dwordx4 v6, s[20:23], s80 offen lds
    s_add_u32 m0, m0, 3072
    s_add_u32 s80, s80, 86016
    buffer_load_dwordx4 v6, s[20:23], s80 offen lds
    s_add_u32 m0, m0, 3072
    s_add_u32 s80, s80, 86016
    buffer_load_dwordx4 v6, s[20:23], s80 offen lds
    s_add_u32 m0, m0, 3072
    s_add_u32 s80, s80, 86016
    buffer_load_dwordx4 v6, s[20:23], s80 offen lds
    s_add_u32 m0, m0, 3072
    s_add_u32 s80, s80, 86016
    buffer_load_dwordx4 v6, s[20:23], s80 offen lds
    s_add_u32 m0, m0, 3072
    s_add_u32 s80, s80, 86016
    buffer_load_dwordx4 v6, s[20:23], s80 offen lds
    s_add_u32 m0, m0, 3072
    s_add_u32 s80, s80, 86016
    s_cmp_lt_u32 s79, 2
    s_cbranch_scc0 L_25
    buffer_load_dwordx4 v6, s[20:23], s80 offen lds
L_25:
    s_branch L_20
L_19:
    v_lshrrev_b32 v2, 2, v1
    v_and_b32 v3, 3, v1
    v_lshlrev_b32 v3, 4, v3
    v_mul_u32_u24 v6, 3584, v2
    v_add_u32 v6, v6, v3
    v_mov_b32 v2, 162856
    s_mov_b32 s69, 0
L_sp_26:
    ds_read_b32 v3, v2
    s_add_u32 s69, s69, 1
    s_waitcnt lgkmcnt(0)
    v_readfirstlane_b32 s68, v3
    s_nop 0
    s_cmp_ge_u32 s68, 4
    s_cbranch_scc1 L_spd_27
    s_cmp_gt_u32 s69, 1048576
    s_cbranch_scc1 L_spd_27
    s_sleep 1
    s_branch L_sp_26
L_spd_27:
    s_mul_i32 s80, s79, 57344
    s_lshl_b32 s82, s73, 6
    s_lshl_b32 s81, s79, 10
    s_add_u32 m0, s81, 114688
    s_add_u32 s80, s80, s82
    buffer_load_dwordx4 v6, s[20:23], s80 offen lds
    s_add_u32 m0, m0, 3072
    s_add_u32 s80, s80, 172032
    buffer_load_dwordx4 v6, s[20:23], s80 offen lds
    s_add_u32 m0, m0, 3072
    s_add_u32 s80, s80, 172032
    buffer_load_dwordx4 v6, s[20:23], s80 offen lds
    s_add_u32 m0, m0, 3072
    s_add_u32 s80, s80, 172032
    buffer_load_dwordx4 v6, s[20:23], s80 offen lds
    s_add_u32 m0, m0, 3072
    s_add_u32 s80, s80, 172032
    buffer_load_dwordx4 v6, s[20:23], s80 offen lds
    s_add_u32 m0, m0, 3072
    s_add_u32 s80, s80, 172032
    buffer_load_dwordx4 v6, s[20:23], s80 offen lds
    s_add_u32 m0, m0, 3072
    s_add_u32 s80, s80, 172032
    buffer_load_dwordx4 v6, s[20:23], s80 offen lds
    s_add_u32 m0, m0, 3072
    s_add_u32 s80, s80, 172032
    buffer_load_dwordx4 v6, s[20:23], s80 offen lds
    s_add_u32 m0, m0, 3072
    s_add_u32 s80, s80, 172032
    buffer_load_dwordx4 v6, s[20:23], s80 offen lds
    s_add_u32 m0, m0, 3072
    s_add_u32 s80, s80, 172032
    s_cmp_lt_u32 s79, 1
    s_cbranch_scc0 L_28
    buffer_load_dwordx4 v6, s[20:23], s80 offen lds
L_28:
L_20:
    s_waitcnt vmcnt(0)
    s_mov_b64 exec, 1
    v_mov_b32 v2, 162848
    v_mov_b32 v3, 1
    ds_add_u32 v2, v3
    s_mov_b64 exec, -1
    s_branch L_kvd_18
L_kvpoll_17:
    v_mov_b32 v2, 162816
    s_mov_b32 s69, 0
L_sp_29:
    ds_read_b32 v3, v2
    s_add_u32 s69, s69, 1
    s_waitcnt lgkmcnt(0)
    v_readfirstlane_b32 s68, v3
    s_nop 0
    s_cmp_ge_u32 s68, 8
    s_cbranch_scc1 L_spd_30
    s_cmp_gt_u32 s69, 1048576
    s_cbranch_scc1 L_spd_30
    s_sleep 1
    s_branch L_sp_29
L_spd_30:
    s_lshl_b32 s80, s4, 18
    s_lshl_b32 s81, s5, 14
    s_add_u32 s80, s80, s81
    s_add_u32 s80, s80, 1048576
    s_add_u32 s82, s80, 8192
    v_lshlrev_b32 v2, 7, v1
    buffer_load_dword v54, v2, s[40:43], s80 offen sc1
    buffer_load_dword v55, v2, s[40:43], s82 offen sc1
L_kvd_18:
L_p1done_9:
    v_lshlrev_b32 v2, 4, v1
    s_setprio 3
    s_mov_b32 s82, 0
    s_mov_b32 s83, 8
    s_mov_b32 s84, 8
    s_mov_b32 s85, 8
    s_mov_b32 s86, 0
    v_mov_b32 v4, 162872
    s_mov_b32 s69, 0
L_sp_31:
    ds_read_b32 v5, v4
    s_add_u32 s69, s69, 1
    s_waitcnt lgkmcnt(0)
    v_readfirstlane_b32 s68, v5
    s_nop 0
    s_cmp_ge_u32 s68, 4
    s_cbranch_scc1 L_spd_32
    s_cmp_gt_u32 s69, 1048576
    s_cbranch_scc1 L_spd_32
    s_nop 0
    s_branch L_sp_31
L_spd_32:
    v_add_u32 v3, 143360, v2
    ds_read_b128 v[8:11], v3 offset:0
    ds_read_b128 v[12:15], v3 offset:1024
    ds_read_b128 v[16:19], v3 offset:2048
    ds_read_b128 v[20:23], v3 offset:3072
    ds_read_b128 v[24:27], v3 offset:4096
    ds_read_b128 v[28:31], v3 offset:5120
    ds_read_b128 v[32:35], v3 offset:6144
    ds_read_b128 v[36:39], v3 offset:7168
    v_and_b32 v4, 31, v1
    v_lshlrev_b32 v4, 2, v4
    v_add_u32 v4, 159744, v4
    v_mov_b32 v5, 162880
    ds_read_b32 v44, v5
    ds_read_b32 v40, v4 offset:0
    ds_read_b32 v41, v4 offset:128
    ds_read_b32 v42, v4 offset:256
    ds_read_b32 v43, v4 offset:384
    s_waitcnt lgkmcnt(0)
    v_mul_f32 v40, v40, v44
    v_sqrt_f32 v40, v40
    s_nop 0
    v_mul_f32 v40, 0xbef5c28f, v40
    v_cvt_pk_bf16_f32 v45, v40, v40
    v_lshlrev_b32 v45, 16, v45
    v_sub_f32 v45, v40, v45
    v_cvt_pk_bf16_f32 v40, v40, v45
    v_mul_f32 v41, v41, v44
    v_sqrt_f32 v41, v41
    s_nop 0
    v_mul_f32 v41, 0xbef5c28f, v41
    v_cvt_pk_bf16_f32 v45, v41, v41
    v_lshlrev_b32 v45, 16, v45
    v_sub_f32 v45, v41, v45
    v_cvt_pk_bf16_f32 v41, v41, v45
    v_mul_f32 v42, v42, v44
    v_sqrt_f32 v42, v42
    s_nop 0
    v_mul_f32 v42, 0xbef5c28f, v42
    v_cvt_pk_bf16_f32 v45, v42, v42
    v_lshlrev_b32 v45, 16, v45
    v_sub_f32 v45, v42, v45
    v_cvt_pk_bf16_f32 v42, v42, v45
    v_mul_f32 v43, v43, v44
    v_sqrt_f32 v43, v43
    s_nop 0
    v_mul_f32 v43, 0xbef5c28f, v43
    v_cvt_pk_bf16_f32 v45, v43, v43
    v_lshlrev_b32 v45, 16, v45
    v_sub_f32 v45, v43, v45
    v_cvt_pk_bf16_f32 v43, v43, v45
    s_mov_b32 exec_lo, 0
    v_mov_b32 v14, v40
    v_mov_b32 v22, v41
    v_mov_b32 v30, v42
    v_mov_b32 v38, v43
    s_mov_b64 exec, -1
    s_lshl_b32 s80, s4, 4
    s_lshl_b32 s81, s3, 1
    s_add_u32 s80, s80, s81
    s_mov_b64 exec, 3
    v_add_u32 v6, s80, v1
    v_lshlrev_b32 v6, 7, v6
    v_add_u32 v6, 0, v6
    s_mov_b32 s88, 0
L_poll_33:
    buffer_load_dwordx2 v[4:5], v6, s[40:43], 0 offen sc1
    s_add_u32 s88, s88, 1
    s_waitcnt vmcnt(0)
    v_cmp_ne_u32 vcc, s44, v4
    v_cmp_ne_u32 s[90:91], s45, v5
    s_nop 0
    s_or_b64 vcc, vcc, s[90:91]
    s_cmp_eq_u64 vcc, 0
    s_cbranch_scc1 L_polld_34
    s_cmp_gt_u32 s88, 20480
    s_cbranch_scc1 L_polld_34
    s_sleep 1
    s_branch L_poll_33
L_polld_34:
    s_mov_b64 exec, -1
    s_lshl_b32 s80, s4, 18
    s_lshl_b32 s68, s3, 15
    s_add_u32 s80, s80, s68
    s_add_u32 s80, s80, 1048576
    s_lshr_b32 s81, s5, 1
    s_add_u32 s88, s81, 0
    s_and_b32 s88, s88, 7
    s_lshl_b32 s88, s88, 12
    s_add_u32 s88, s88, s80
    buffer_load_dwordx4 v[56:59], v2, s[40:43], s88 offen sc1
    buffer_load_dwordx4 v[60:63], v2, s[40:43], s88 offen offset:1024 sc1
    s_add_u32 s89, s81, 0
    s_and_b32 s89, s89, 7
    s_lshl_b32 s89, s89, 12
    s_add_u32 s89, s89, s80
    buffer_load_dwordx4 v[64:67], v2, s[40:43], s89 offen offset:2048 sc1
    buffer_load_dwordx4 v[68:71], v2, s[40:43], s89 offen offset:3072 sc1
    s_add_u32 s88, s81, 1
    s_and_b32 s88, s88, 7
    s_lshl_b32 s88, s88, 12
    s_add_u32 s88, s88, s80
    buffer_load_dwordx4 v[72:75], v2, s[40:43], s88 offen sc1
    buffer_load_dwordx4 v[76:79], v2, s[40:43], s88 offen offset:1024 sc1
    s_add_u32 s89, s81, 1
    s_and_b32 s89, s89, 7
    s_lshl_b32 s89, s89, 12
    s_add_u32 s89, s89, s80
    buffer_load_dwordx4 v[80:83], v2, s[40:43], s89 offen offset:2048 sc1
    buffer_load_dwordx4 v[84:87], v2, s[40:43], s89 offen offset:3072 sc1
    s_branch L_attn_main
L_attn_retry:
    v_add_u32 v3, 143360, v2
    ds_read_b128 v[8:11], v3 offset:0
    ds_read_b128 v[12:15], v3 offset:1024
    ds_read_b128 v[16:19], v3 offset:2048
    ds_read_b128 v[20:23], v3 offset:3072
    ds_read_b128 v[24:27], v3 offset:4096
    ds_read_b128 v[28:31], v3 offset:5120
    ds_read_b128 v[32:35], v3 offset:6144
    ds_read_b128 v[36:39], v3 offset:7168
    s_waitcnt lgkmcnt(0)
    s_mov_b32 exec_lo, 0
    v_mov_b32 v14, 0
    v_mov_b32 v22, 0
    v_mov_b32 v30, 0
    v_mov_b32 v38, 0
    s_mov_b64 exec, -1
    v_mov_b32 v3, 0xff800000
    v_mov_b32 v4, 0xff800000
    v_mov_b32 v5, 0xff800000
    v_mov_b32 v6, 0xff800000
    s_mov_b32 s91, 0
L_safel_35:
    s_lshl_b32 s88, s91, 12
    s_add_u32 s88, s88, s80
    buffer_load_dwordx4 v[56:59], v2, s[40:43], s88 offen sc1
    buffer_load_dwordx4 v[60:63], v2, s[40:43], s88 offen offset:1024 sc1
    s_waitcnt vmcnt(0)
    v_mfma_f32_32x32x16_bf16 v[40:55], v[56:59], v[8:11], 0
    v_mfma_f32_32x32x16_bf16 v[40:55], v[60:63], v[12:15], v[40:55]
    v_mfma_f32_32x32x16_bf16 v[88:103], v[56:59], v[16:19], 0
    v_mfma_f32_32x32x16_bf16 v[88:103], v[60:63], v[20:23], v[88:103]
    s_nop 9
    v_max3_f32 v3, v3, v40, v41
    v_max3_f32 v3, v3, v42, v43
    v_max3_f32 v3, v3, v44, v45
    v_max3_f32 v3, v3, v46, v47
    v_max3_f32 v3, v3, v48, v49
    v_max3_f32 v3, v3, v50, v51
    v_max3_f32 v3, v3, v52, v53
    v_max3_f32 v3, v3, v54, v55
    v_mfma_f32_32x32x16_bf16 v[40:55], v[56:59], v[24:27], 0
    v_mfma_f32_32x32x16_bf16 v[40:55], v[60:63], v[28:31], v[40:55]
    v_max3_f32 v4, v4, v88, v89
    v_max3_f32 v4, v4, v90, v91
    v_max3_f32 v4, v4, v92, v93
    v_max3_f32 v4, v4, v94, v95
    v_max3_f32 v4, v4, v96, v97
    v_max3_f32 v4, v4, v98, v99
    v_max3_f32 v4, v4, v100, v101
    v_max3_f32 v4, v4, v102, v103
    v_mfma_f32_32x32x16_bf16 v[88:103], v[56:59], v[32:35], 0
    v_mfma_f32_32x32x16_bf16 v[88:103], v[60:63], v[36:39], v[88:103]
    s_nop 1
    v_max3_f32 v5, v5, v40, v41
    v_max3_f32 v5, v5, v42, v43
    v_max3_f32 v5, v5, v44, v45
    v_max3_f32 v5, v5, v46, v47
    v_max3_f32 v5, v5, v48, v49
    v_max3_f32 v5, v5, v50, v51
    v_max3_f32 v5, v5, v52, v53
    v_max3_f32 v5, v5, v54, v55
    s_nop 1
    v_max3_f32 v6, v6, v88, v89
    v_max3_f32 v6, v6, v90, v91
    v_max3_f32 v6, v6, v92, v93
    v_max3_f32 v6, v6, v94, v95
    v_max3_f32 v6, v6, v96, v97
    v_max3_f32 v6, v6, v98, v99
    v_max3_f32 v6, v6, v100, v101
    v_max3_f32 v6, v6, v102, v103
    s_add_u32 s91, s91, 1
    s_cmp_lt_u32 s91, 8
    s_cbranch_scc1 L_safel_35
    s_add_u32 s88, s81, 0
    s_and_b32 s88, s88, 7
    s_lshl_b32 s88, s88, 12
    s_add_u32 s88, s88, s80
    buffer_load_dwordx4 v[56:59], v2, s[40:43], s88 offen sc1
    buffer_load_dwordx4 v[60:63], v2, s[40:43], s88 offen offset:1024 sc1
    s_add_u32 s89, s81, 0
    s_and_b32 s89, s89, 7
    s_lshl_b32 s89, s89, 12
    s_add_u32 s89, s89, s80
    buffer_load_dwordx4 v[64:67], v2, s[40:43], s89 offen offset:2048 sc1
    buffer_load_dwordx4 v[68:71], v2, s[40:43], s89 offen offset:3072 sc1
    s_add_u32 s88, s81, 1
    s_and_b32 s88, s88, 7
    s_lshl_b32 s88, s88, 12
    s_add_u32 s88, s88, s80
    buffer_load_dwordx4 v[72:75], v2, s[40:43], s88 offen sc1
    buffer_load_dwordx4 v[76:79], v2, s[40:43], s88 offen offset:1024 sc1
    s_add_u32 s89, s81, 1
    s_and_b32 s89, s89, 7
    s_lshl_b32 s89, s89, 12
    s_add_u32 s89, s89, s80
    buffer_load_dwordx4 v[80:83], v2, s[40:43], s89 offen offset:2048 sc1
    buffer_load_dwordx4 v[84:87], v2, s[40:43], s89 offen offset:3072 sc1
    v_mov_b32 v7, v3
    s_nop 1
    v_permlane32_swap_b32 v7, v3
    v_max_f32 v3, v3, v7
    v_mov_b32 v7, v4
    s_nop 1
    v_permlane32_swap_b32 v7, v4
    v_max_f32 v4, v4, v7
    v_mov_b32 v7, v5
    s_nop 1
    v_permlane32_swap_b32 v7, v5
    v_max_f32 v5, v5, v7
    v_mov_b32 v7, v6
    s_nop 1
    v_permlane32_swap_b32 v7, v6
    v_max_f32 v6, v6, v7
    v_and_b32 v7, 31, v1
    v_lshlrev_b32 v7, 5, v7
    v_add_u32 v7, 151552, v7
    s_lshl_b32 s68, s3, 2
    v_add_u32 v40, s68, v7
    ds_write_b32 v40, v3 offset:0
    ds_write_b32 v40, v4 offset:1024
    ds_write_b32 v40, v5 offset:2048
    ds_write_b32 v40, v6 offset:3072
    s_waitcnt lgkmcnt(0)
    s_mov_b64 exec, 1
    v_mov_b32 v4, 162824
    v_mov_b32 v5, 1
    ds_add_u32 v4, v5
    s_mov_b64 exec, -1
    v_mov_b32 v4, 162824
    s_mov_b32 s69, 0
L_sp_36:
    ds_read_b32 v5, v4
    s_add_u32 s69, s69, 1
    s_waitcnt lgkmcnt(0)
    v_readfirstlane_b32 s68, v5
    s_nop 0
    s_cmp_ge_u32 s68, s83
    s_cbranch_scc1 L_spd_37
    s_cmp_gt_u32 s69, 1048576
    s_cbranch_scc1 L_spd_37
    s_sleep 1
    s_branch L_sp_36
L_spd_37:
    s_add_u32 s83, s83, 8
    ds_read_b128 v[40:43], v7 offset:0
    ds_read_b128 v[44:47], v7 offset:16
    s_waitcnt lgkmcnt(0)
    v_max3_f32 v3, v40, v41, v42
    v_max3_f32 v3, v3, v43, v44
    v_max3_f32 v3, v3, v45, v46
    v_max_f32 v3, v3, v47
    v_add_f32 v3, 0x42a00000, v3
    v_sub_f32 v3, 0, v3
    v_cvt_pk_bf16_f32 v4, v3, v3
    v_lshlrev_b32 v4, 16, v4
    v_sub_f32 v4, v3, v4
    v_cvt_pk_bf16_f32 v4, v3, v4
    s_mov_b32 exec_lo, 0
    v_mov_b32 v14, v4
    s_mov_b64 exec, -1
    ds_read_b128 v[40:43], v7 offset:1024
    ds_read_b128 v[44:47], v7 offset:1040
    s_waitcnt lgkmcnt(0)
    v_max3_f32 v3, v40, v41, v42
    v_max3_f32 v3, v3, v43, v44
    v_max3_f32 v3, v3, v45, v46
    v_max_f32 v3, v3, v47
    v_add_f32 v3, 0x42a00000, v3
    v_sub_f32 v3, 0, v3
    v_cvt_pk_bf16_f32 v4, v3, v3
    v_lshlrev_b32 v4, 16, v4
    v_sub_f32 v4, v3, v4
    v_cvt_pk_bf16_f32 v4, v3, v4
    s_mov_b32 exec_lo, 0
    v_mov_b32 v22, v4
    s_mov_b64 exec, -1
    ds_read_b128 v[40:43], v7 offset:2048
    ds_read_b128 v[44:47], v7 offset:2064
    s_waitcnt lgkmcnt(0)
    v_max3_f32 v3, v40, v41, v42
    v_max3_f32 v3, v3, v43, v44
    v_max3_f32 v3, v3, v45, v46
    v_max_f32 v3, v3, v47
    v_add_f32 v3, 0x42a00000, v3
    v_sub_f32 v3, 0, v3
    v_cvt_pk_bf16_f32 v4, v3, v3
    v_lshlrev_b32 v4, 16, v4
    v_sub_f32 v4, v3, v4
    v_cvt_pk_bf16_f32 v4, v3, v4
    s_mov_b32 exec_lo, 0
    v_mov_b32 v30, v4
    s_mov_b64 exec, -1
    ds_read_b128 v[40:43], v7 offset:3072
    ds_read_b128 v[44:47], v7 offset:3088
    s_waitcnt lgkmcnt(0)
    v_max3_f32 v3, v40, v41, v42
    v_max3_f32 v3, v3, v43, v44
    v_max3_f32 v3, v3, v45, v46
    v_max_f32 v3, v3, v47
    v_add_f32 v3, 0x42a00000, v3
    v_sub_f32 v3, 0, v3
    v_cvt_pk_bf16_f32 v4, v3, v3
    v_lshlrev_b32 v4, 16, v4
    v_sub_f32 v4, v3, v4
    v_cvt_pk_bf16_f32 v4, v3, v4
    s_mov_b32 exec_lo, 0
    v_mov_b32 v38, v4
    s_mov_b64 exec, -1
L_attn_main:
    s_mul_i32 s68, s3, 16384
    v_add_u32 v3, s68, v2
    v_and_b32 v7, 31, v1
    v_lshlrev_b32 v7, 5, v7
    s_lshl_b32 s68, s3, 2
    s_add_u32 s68, s68, 151552
    v_add_u32 v7, s68, v7
    s_waitcnt vmcnt(6)
    v_mfma_f32_32x32x16_bf16 v[40:55], v[56:59], v[8:11], 0
    v_mfma_f32_32x32x16_bf16 v[40:55], v[60:63], v[12:15], v[40:55]
    s_setprio 2
    s_nop 10
    v_exp_f32 v40, v40
    v_exp_f32 v41, v41
    v_exp_f32 v42, v42
    v_exp_f32 v43, v43
    v_exp_f32 v44, v44
    v_exp_f32 v45, v45
    v_mfma_f32_32x32x16_bf16 v[88:103], v[56:59], v[16:19], 0
    v_cvt_pk_bf16_f32 v40, v40, v41
    v_exp_f32 v46, v46
    v_exp_f32 v47, v47
    v_cvt_pk_bf16_f32 v41, v42, v43
    v_exp_f32 v48, v48
    v_exp_f32 v49, v49
    v_mfma_f32_32x32x16_bf16 v[88:103], v[60:63], v[20:23], v[88:103]
    v_cvt_pk_bf16_f32 v42, v44, v45
    v_exp_f32 v50, v50
    v_exp_f32 v51, v51
    v_cvt_pk_bf16_f32 v43, v46, v47
    v_exp_f32 v52, v52
    v_exp_f32 v53, v53
    s_waitcnt vmcnt(4)
    v_mfma_f32_32x32x16_bf16 v[104:119], v[64:67], v[40:43], 0
    v_exp_f32 v54, v54
    v_exp_f32 v55, v55
    v_cvt_pk_bf16_f32 v44, v48, v49
    v_cvt_pk_bf16_f32 v45, v50, v51
    v_cvt_pk_bf16_f32 v46, v52, v53
    v_cvt_pk_bf16_f32 v47, v54, v55
    v_exp_f32 v88, v88
    v_exp_f32 v89, v89
    v_mfma_f32_32x32x16_bf16 v[104:119], v[68:71], v[44:47], v[104:119]
    v_exp_f32 v90, v90
    v_exp_f32 v91, v91
    v_exp_f32 v92, v92
    v_exp_f32 v93, v93
    v_mfma_f32_32x32x16_bf16 v[40:55], v[56:59], v[24:27], 0
    v_cvt_pk_bf16_f32 v88, v88, v89
    v_exp_f32 v94, v94
    v_exp_f32 v95, v95
    v_cvt_pk_bf16_f32 v89, v90, v91
    v_exp_f32 v96, v96
    v_exp_f32 v97, v97
    v_mfma_f32_32x32x16_bf16 v[40:55], v[60:63], v[28:31], v[40:55]
    v_cvt_pk_bf16_f32 v90, v92, v93
    v_exp_f32 v98, v98
    v_exp_f32 v99, v99
    v_cvt_pk_bf16_f32 v91, v94, v95
    v_exp_f32 v100, v100
    v_exp_f32 v101, v101
    v_mfma_f32_32x32x16_bf16 v[120:135], v[64:67], v[88:91], 0
    v_exp_f32 v102, v102
    v_exp_f32 v103, v103
    v_cvt_pk_bf16_f32 v92, v96, v97
    v_cvt_pk_bf16_f32 v93, v98, v99
    v_cvt_pk_bf16_f32 v94, v100, v101
    v_cvt_pk_bf16_f32 v95, v102, v103
    v_exp_f32 v40, v40
    v_exp_f32 v41, v41
    v_mfma_f32_32x32x16_bf16 v[120:135], v[68:71], v[92:95], v[120:135]
    v_exp_f32 v42, v42
    v_exp_f32 v43, v43
    v_exp_f32 v44, v44
    v_exp_f32 v45, v45
    v_mfma_f32_32x32x16_bf16 v[88:103], v[56:59], v[32:35], 0
    v_cvt_pk_bf16_f32 v40, v40, v41
    v_exp_f32 v46, v46
    v_exp_f32 v47, v47
    v_cvt_pk_bf16_f32 v41, v42, v43
    v_exp_f32 v48, v48
    v_exp_f32 v49, v49
    v_mfma_f32_32x32x16_bf16 v[88:103], v[60:63], v[36:39], v[88:103]
    s_add_u32 s88, s81, 2
    s_and_b32 s88, s88, 7
    s_lshl_b32 s88, s88, 12
    s_add_u32 s88, s88, s80
    buffer_load_dwordx4 v[56:59], v2, s[40:43], s88 offen sc1
    buffer_load_dwordx4 v[60:63], v2, s[40:43], s88 offen offset:1024 sc1
    v_cvt_pk_bf16_f32 v42, v44, v45
    v_exp_f32 v50, v50
    v_exp_f32 v51, v51
    v_cvt_pk_bf16_f32 v43, v46, v47
    v_exp_f32 v52, v52
    v_exp_f32 v53, v53
    v_mfma_f32_32x32x16_bf16 v[136:151], v[64:67], v[40:43], 0
    v_exp_f32 v54, v54
    v_exp_f32 v55, v55
    v_cvt_pk_bf16_f32 v44, v48, v49
    v_cvt_pk_bf16_f32 v45, v50, v51
    v_cvt_pk_bf16_f32 v46, v52, v53
    v_cvt_pk_bf16_f32 v47, v54, v55
    v_exp_f32 v88, v88
    v_exp_f32 v89, v89
    v_mfma_f32_32x32x16_bf16 v[136:151], v[68:71], v[44:47], v[136:151]
    v_exp_f32 v90, v90
    v_exp_f32 v91, v91
    v_exp_f32 v92, v92
    v_exp_f32 v93, v93
    s_waitcnt vmcnt(4)
    v_mfma_f32_32x32x16_bf16 v[40:55], v[72:75], v[8:11], 0
    v_cvt_pk_bf16_f32 v88, v88, v89
    v_exp_f32 v94, v94
    v_exp_f32 v95, v95
    v_cvt_pk_bf16_f32 v89, v90, v91
    v_exp_f32 v96, v96
    v_exp_f32 v97, v97
    v_mfma_f32_32x32x16_bf16 v[40:55], v[76:79], v[12:15], v[40:55]
    v_cvt_pk_bf16_f32 v90, v92, v93
    v_exp_f32 v98, v98
    v_exp_f32 v99, v99
    v_cvt_pk_bf16_f32 v91, v94, v95
    v_exp_f32 v100, v100
    v_exp_f32 v101, v101
    v_mfma_f32_32x32x16_bf16 v[152:167], v[64:67], v[88:91], 0
    v_exp_f32 v102, v102
    v_exp_f32 v103, v103
    v_cvt_pk_bf16_f32 v92, v96, v97
    v_cvt_pk_bf16_f32 v93, v98, v99
    v_cvt_pk_bf16_f32 v94, v100, v101
    v_cvt_pk_bf16_f32 v95, v102, v103
    v_exp_f32 v40, v40
    v_exp_f32 v41, v41
    v_mfma_f32_32x32x16_bf16 v[152:167], v[68:71], v[92:95], v[152:167]
    s_add_u32 s89, s81, 2
    s_and_b32 s89, s89, 7
    s_lshl_b32 s89, s89, 12
    s_add_u32 s89, s89, s80
    buffer_load_dwordx4 v[64:67], v2, s[40:43], s89 offen offset:2048 sc1
    buffer_load_dwordx4 v[68:71], v2, s[40:43], s89 offen offset:3072 sc1
    v_exp_f32 v42, v42
    v_exp_f32 v43, v43
    v_exp_f32 v44, v44
    v_exp_f32 v45, v45
    v_mfma_f32_32x32x16_bf16 v[88:103], v[72:75], v[16:19], 0
    v_cvt_pk_bf16_f32 v40, v40, v41
    v_exp_f32 v46, v46
    v_exp_f32 v47, v47
    v_cvt_pk_bf16_f32 v41, v42, v43
    v_exp_f32 v48, v48
    v_exp_f32 v49, v49
    v_mfma_f32_32x32x16_bf16 v[88:103], v[76:79], v[20:23], v[88:103]
    v_cvt_pk_bf16_f32 v42, v44, v45
    v_exp_f32 v50, v50
    v_exp_f32 v51, v51
    v_cvt_pk_bf16_f32 v43, v46, v47
    v_exp_f32 v52, v52
    v_exp_f32 v53, v53
    s_waitcnt vmcnt(4)
    v_mfma_f32_32x32x16_bf16 v[104:119], v[80:83], v[40:43], v[104:119]
    v_exp_f32 v54, v54
    v_exp_f32 v55, v55
    v_cvt_pk_bf16_f32 v44, v48, v49
    v_cvt_pk_bf16_f32 v45, v50, v51
    v_cvt_pk_bf16_f32 v46, v52, v53
    v_cvt_pk_bf16_f32 v47, v54, v55
    v_exp_f32 v88, v88
    v_exp_f32 v89, v89
    v_mfma_f32_32x32x16_bf16 v[104:119], v[84:87], v[44:47], v[104:119]
    v_exp_f32 v90, v90
    v_exp_f32 v91, v91
    v_exp_f32 v92, v92
    v_exp_f32 v93, v93
    v_mfma_f32_32x32x16_bf16 v[40:55], v[72:75], v[24:27], 0
    v_cvt_pk_bf16_f32 v88, v88, v89
    v_exp_f32 v94, v94
    v_exp_f32 v95, v95
    v_cvt_pk_bf16_f32 v89, v90, v91
    v_exp_f32 v96, v96
    v_exp_f32 v97, v97
    v_mfma_f32_32x32x16_bf16 v[40:55], v[76:79], v[28:31], v[40:55]
    v_cvt_pk_bf16_f32 v90, v92, v93
    v_exp_f32 v98, v98
    v_exp_f32 v99, v99
    v_cvt_pk_bf16_f32 v91, v94, v95
    v_exp_f32 v100, v100
    v_exp_f32 v101, v101
    v_mfma_f32_32x32x16_bf16 v[120:135], v[80:83], v[88:91], v[120:135]
    v_exp_f32 v102, v102
    v_exp_f32 v103, v103
    v_cvt_pk_bf16_f32 v92, v96, v97
    v_cvt_pk_bf16_f32 v93, v98, v99
    v_cvt_pk_bf16_f32 v94, v100, v101
    v_cvt_pk_bf16_f32 v95, v102, v103
    v_exp_f32 v40, v40
    v_exp_f32 v41, v41
    v_mfma_f32_32x32x16_bf16 v[120:135], v[84:87], v[92:95], v[120:135]
    v_exp_f32 v42, v42
    v_exp_f32 v43, v43
    v_exp_f32 v44, v44
    v_exp_f32 v45, v45
    v_mfma_f32_32x32x16_bf16 v[88:103], v[72:75], v[32:35], 0
    v_cvt_pk_bf16_f32 v40, v40, v41
    v_exp_f32 v46, v46
    v_exp_f32 v47, v47
    v_cvt_pk_bf16_f32 v41, v42, v43
    v_exp_f32 v48, v48
    v_exp_f32 v49, v49
    v_mfma_f32_32x32x16_bf16 v[88:103], v[76:79], v[36:39], v[88:103]
    s_add_u32 s88, s81, 3
    s_and_b32 s88, s88, 7
    s_lshl_b32 s88, s88, 12
    s_add_u32 s88, s88, s80
    buffer_load_dwordx4 v[72:75], v2, s[40:43], s88 offen sc1
    buffer_load_dwordx4 v[76:79], v2, s[40:43], s88 offen offset:1024 sc1
    v_cvt_pk_bf16_f32 v42, v44, v45
    v_exp_f32 v50, v50
    v_exp_f32 v51, v51
    v_cvt_pk_bf16_f32 v43, v46, v47
    v_exp_f32 v52, v52
    v_exp_f32 v53, v53
    v_mfma_f32_32x32x16_bf16 v[136:151], v[80:83], v[40:43], v[136:151]
    v_exp_f32 v54, v54
    v_exp_f32 v55, v55
    v_cvt_pk_bf16_f32 v44, v48, v49
    v_cvt_pk_bf16_f32 v45, v50, v51
    v_cvt_pk_bf16_f32 v46, v52, v53
    v_cvt_pk_bf16_f32 v47, v54, v55
    v_exp_f32 v88, v88
    v_exp_f32 v89, v89
    v_mfma_f32_32x32x16_bf16 v[136:151], v[84:87], v[44:47], v[136:151]
    v_exp_f32 v90, v90
    v_exp_f32 v91, v91
    v_exp_f32 v92, v92
    v_exp_f32 v93, v93
    s_waitcnt vmcnt(4)
    v_mfma_f32_32x32x16_bf16 v[40:55], v[56:59], v[8:11], 0
    v_cvt_pk_bf16_f32 v88, v88, v89
    v_exp_f32 v94, v94
    v_exp_f32 v95, v95
    v_cvt_pk_bf16_f32 v89, v90, v91
    v_exp_f32 v96, v96
    v_exp_f32 v97, v97
    v_mfma_f32_32x32x16_bf16 v[40:55], v[60:63], v[12:15], v[40:55]
    v_cvt_pk_bf16_f32 v90, v92, v93
    v_exp_f32 v98, v98
    v_exp_f32 v99, v99
    v_cvt_pk_bf16_f32 v91, v94, v95
    v_exp_f32 v100, v100
    v_exp_f32 v101, v101
    v_mfma_f32_32x32x16_bf16 v[152:167], v[80:83], v[88:91], v[152:167]
    v_exp_f32 v102, v102
    v_exp_f32 v103, v103
    v_cvt_pk_bf16_f32 v92, v96, v97
    v_cvt_pk_bf16_f32 v93, v98, v99
    v_cvt_pk_bf16_f32 v94, v100, v101
    v_cvt_pk_bf16_f32 v95, v102, v103
    s_setprio 2
    v_exp_f32 v40, v40
    v_exp_f32 v41, v41
    v_mfma_f32_32x32x16_bf16 v[152:167], v[84:87], v[92:95], v[152:167]
    s_add_u32 s89, s81, 3
    s_and_b32 s89, s89, 7
    s_lshl_b32 s89, s89, 12
    s_add_u32 s89, s89, s80
    buffer_load_dwordx4 v[80:83], v2, s[40:43], s89 offen offset:2048 sc1
    buffer_load_dwordx4 v[84:87], v2, s[40:43], s89 offen offset:3072 sc1
    v_exp_f32 v42, v42
    v_exp_f32 v43, v43
    v_exp_f32 v44, v44
    v_exp_f32 v45, v45
    v_mfma_f32_32x32x16_bf16 v[88:103], v[56:59], v[16:19], 0
    v_cvt_pk_bf16_f32 v40, v40, v41
    v_exp_f32 v46, v46
    v_exp_f32 v47, v47
    v_cvt_pk_bf16_f32 v41, v42, v43
    v_exp_f32 v48, v48
    v_exp_f32 v49, v49
    v_mfma_f32_32x32x16_bf16 v[88:103], v[60:63], v[20:23], v[88:103]
    v_cvt_pk_bf16_f32 v42, v44, v45
    v_exp_f32 v50, v50
    v_exp_f32 v51, v51
    v_cvt_pk_bf16_f32 v43, v46, v47
    v_exp_f32 v52, v52
    v_exp_f32 v53, v53
    s_waitcnt vmcnt(4)
    v_mfma_f32_32x32x16_bf16 v[104:119], v[64:67], v[40:43], v[104:119]
    v_exp_f32 v54, v54
    v_exp_f32 v55, v55
    v_cvt_pk_bf16_f32 v44, v48, v49
    v_cvt_pk_bf16_f32 v45, v50, v51
    v_cvt_pk_bf16_f32 v46, v52, v53
    v_cvt_pk_bf16_f32 v47, v54, v55
    v_exp_f32 v88, v88
    v_exp_f32 v89, v89
    v_mfma_f32_32x32x16_bf16 v[104:119], v[68:71], v[44:47], v[104:119]
    v_exp_f32 v90, v90
    v_exp_f32 v91, v91
    v_exp_f32 v92, v92
    v_exp_f32 v93, v93
    v_mfma_f32_32x32x16_bf16 v[40:55], v[56:59], v[24:27], 0
    v_cvt_pk_bf16_f32 v88, v88, v89
    v_exp_f32 v94, v94
    v_exp_f32 v95, v95
    v_cvt_pk_bf16_f32 v89, v90, v91
    v_exp_f32 v96, v96
    v_exp_f32 v97, v97
    v_mfma_f32_32x32x16_bf16 v[40:55], v[60:63], v[28:31], v[40:55]
    v_cvt_pk_bf16_f32 v90, v92, v93
    v_exp_f32 v98, v98
    v_exp_f32 v99, v99
    v_cvt_pk_bf16_f32 v91, v94, v95
    v_exp_f32 v100, v100
    v_exp_f32 v101, v101
    v_mfma_f32_32x32x16_bf16 v[120:135], v[64:67], v[88:91], v[120:135]
    v_exp_f32 v102, v102
    v_exp_f32 v103, v103
    v_cvt_pk_bf16_f32 v92, v96, v97
    v_cvt_pk_bf16_f32 v93, v98, v99
    v_cvt_pk_bf16_f32 v94, v100, v101
    v_cvt_pk_bf16_f32 v95, v102, v103
    v_exp_f32 v40, v40
    v_exp_f32 v41, v41
    v_mfma_f32_32x32x16_bf16 v[120:135], v[68:71], v[92:95], v[120:135]
    v_exp_f32 v42, v42
    v_exp_f32 v43, v43
    v_exp_f32 v44, v44
    v_exp_f32 v45, v45
    v_mfma_f32_32x32x16_bf16 v[88:103], v[56:59], v[32:35], 0
    v_cvt_pk_bf16_f32 v40, v40, v41
    v_exp_f32 v46, v46
    v_exp_f32 v47, v47
    v_cvt_pk_bf16_f32 v41, v42, v43
    v_exp_f32 v48, v48
    v_exp_f32 v49, v49
    v_mfma_f32_32x32x16_bf16 v[88:103], v[60:63], v[36:39], v[88:103]
    s_add_u32 s88, s81, 4
    s_and_b32 s88, s88, 7
    s_lshl_b32 s88, s88, 12
    s_add_u32 s88, s88, s80
    buffer_load_dwordx4 v[56:59], v2, s[40:43], s88 offen sc1
    buffer_load_dwordx4 v[60:63], v2, s[40:43], s88 offen offset:1024 sc1
    v_cvt_pk_bf16_f32 v42, v44, v45
    v_exp_f32 v50, v50
    v_exp_f32 v51, v51
    v_cvt_pk_bf16_f32 v43, v46, v47
    v_exp_f32 v52, v52
    v_exp_f32 v53, v53
    v_mfma_f32_32x32x16_bf16 v[136:151], v[64:67], v[40:43], v[136:151]
    v_exp_f32 v54, v54
    v_exp_f32 v55, v55
    v_cvt_pk_bf16_f32 v44, v48, v49
    v_cvt_pk_bf16_f32 v45, v50, v51
    v_cvt_pk_bf16_f32 v46, v52, v53
    v_cvt_pk_bf16_f32 v47, v54, v55
    v_exp_f32 v88, v88
    v_exp_f32 v89, v89
    v_mfma_f32_32x32x16_bf16 v[136:151], v[68:71], v[44:47], v[136:151]
    v_exp_f32 v90, v90
    v_exp_f32 v91, v91
    v_exp_f32 v92, v92
    v_exp_f32 v93, v93
    s_waitcnt vmcnt(4)
    v_mfma_f32_32x32x16_bf16 v[40:55], v[72:75], v[8:11], 0
    v_cvt_pk_bf16_f32 v88, v88, v89
    v_exp_f32 v94, v94
    v_exp_f32 v95, v95
    v_cvt_pk_bf16_f32 v89, v90, v91
    v_exp_f32 v96, v96
    v_exp_f32 v97, v97
    v_mfma_f32_32x32x16_bf16 v[40:55], v[76:79], v[12:15], v[40:55]
    v_cvt_pk_bf16_f32 v90, v92, v93
    v_exp_f32 v98, v98
    v_exp_f32 v99, v99
    v_cvt_pk_bf16_f32 v91, v94, v95
    v_exp_f32 v100, v100
    v_exp_f32 v101, v101
    v_mfma_f32_32x32x16_bf16 v[152:167], v[64:67], v[88:91], v[152:167]
    v_exp_f32 v102, v102
    v_exp_f32 v103, v103
    v_cvt_pk_bf16_f32 v92, v96, v97
    v_cvt_pk_bf16_f32 v93, v98, v99
    v_cvt_pk_bf16_f32 v94, v100, v101
    v_cvt_pk_bf16_f32 v95, v102, v103
    v_exp_f32 v40, v40
    v_exp_f32 v41, v41
    v_mfma_f32_32x32x16_bf16 v[152:167], v[68:71], v[92:95], v[152:167]
    s_add_u32 s89, s81, 4
    s_and_b32 s89, s89, 7
    s_lshl_b32 s89, s89, 12
    s_add_u32 s89, s89, s80
    buffer_load_dwordx4 v[64:67], v2, s[40:43], s89 offen offset:2048 sc1
    buffer_load_dwordx4 v[68:71], v2, s[40:43], s89 offen offset:3072 sc1
    v_exp_f32 v42, v42
    v_exp_f32 v43, v43
    v_exp_f32 v44, v44
    v_exp_f32 v45, v45
    v_mfma_f32_32x32x16_bf16 v[88:103], v[72:75], v[16:19], 0
    v_cvt_pk_bf16_f32 v40, v40, v41
    v_exp_f32 v46, v46
    v_exp_f32 v47, v47
    v_cvt_pk_bf16_f32 v41, v42, v43
    v_exp_f32 v48, v48
    v_exp_f32 v49, v49
    v_mfma_f32_32x32x16_bf16 v[88:103], v[76:79], v[20:23], v[88:103]
    v_cvt_pk_bf16_f32 v42, v44, v45
    v_exp_f32 v50, v50
    v_exp_f32 v51, v51
    v_cvt_pk_bf16_f32 v43, v46, v47
    v_exp_f32 v52, v52
    v_exp_f32 v53, v53
    s_waitcnt vmcnt(4)
    v_mfma_f32_32x32x16_bf16 v[104:119], v[80:83], v[40:43], v[104:119]
    v_exp_f32 v54, v54
    v_exp_f32 v55, v55
    v_cvt_pk_bf16_f32 v44, v48, v49
    v_cvt_pk_bf16_f32 v45, v50, v51
    v_cvt_pk_bf16_f32 v46, v52, v53
    v_cvt_pk_bf16_f32 v47, v54, v55
    v_exp_f32 v88, v88
    v_exp_f32 v89, v89
    v_mfma_f32_32x32x16_bf16 v[104:119], v[84:87], v[44:47], v[104:119]
    v_exp_f32 v90, v90
    v_exp_f32 v91, v91
    v_exp_f32 v92, v92
    v_exp_f32 v93, v93
    v_mfma_f32_32x32x16_bf16 v[40:55], v[72:75], v[24:27], 0
    v_cvt_pk_bf16_f32 v88, v88, v89
    v_exp_f32 v94, v94
    v_exp_f32 v95, v95
    v_cvt_pk_bf16_f32 v89, v90, v91
    v_exp_f32 v96, v96
    v_exp_f32 v97, v97
    v_mfma_f32_32x32x16_bf16 v[40:55], v[76:79], v[28:31], v[40:55]
    v_cvt_pk_bf16_f32 v90, v92, v93
    v_exp_f32 v98, v98
    v_exp_f32 v99, v99
    v_cvt_pk_bf16_f32 v91, v94, v95
    v_exp_f32 v100, v100
    v_exp_f32 v101, v101
    v_mfma_f32_32x32x16_bf16 v[120:135], v[80:83], v[88:91], v[120:135]
    v_exp_f32 v102, v102
    v_exp_f32 v103, v103
    v_cvt_pk_bf16_f32 v92, v96, v97
    v_cvt_pk_bf16_f32 v93, v98, v99
    v_cvt_pk_bf16_f32 v94, v100, v101
    v_cvt_pk_bf16_f32 v95, v102, v103
    v_exp_f32 v40, v40
    v_exp_f32 v41, v41
    v_mfma_f32_32x32x16_bf16 v[120:135], v[84:87], v[92:95], v[120:135]
    v_exp_f32 v42, v42
    v_exp_f32 v43, v43
    v_exp_f32 v44, v44
    v_exp_f32 v45, v45
    v_mfma_f32_32x32x16_bf16 v[88:103], v[72:75], v[32:35], 0
    v_cvt_pk_bf16_f32 v40, v40, v41
    v_exp_f32 v46, v46
    v_exp_f32 v47, v47
    v_cvt_pk_bf16_f32 v41, v42, v43
    v_exp_f32 v48, v48
    v_exp_f32 v49, v49
    v_mfma_f32_32x32x16_bf16 v[88:103], v[76:79], v[36:39], v[88:103]
    s_add_u32 s88, s81, 5
    s_and_b32 s88, s88, 7
    s_lshl_b32 s88, s88, 12
    s_add_u32 s88, s88, s80
    buffer_load_dwordx4 v[72:75], v2, s[40:43], s88 offen sc1
    buffer_load_dwordx4 v[76:79], v2, s[40:43], s88 offen offset:1024 sc1
    v_cvt_pk_bf16_f32 v42, v44, v45
    v_exp_f32 v50, v50
    v_exp_f32 v51, v51
    v_cvt_pk_bf16_f32 v43, v46, v47
    v_exp_f32 v52, v52
    v_exp_f32 v53, v53
    v_mfma_f32_32x32x16_bf16 v[136:151], v[80:83], v[40:43], v[136:151]
    v_exp_f32 v54, v54
    v_exp_f32 v55, v55
    v_cvt_pk_bf16_f32 v44, v48, v49
    v_cvt_pk_bf16_f32 v45, v50, v51
    v_cvt_pk_bf16_f32 v46, v52, v53
    v_cvt_pk_bf16_f32 v47, v54, v55
    v_exp_f32 v88, v88
    v_exp_f32 v89, v89
    v_mfma_f32_32x32x16_bf16 v[136:151], v[84:87], v[44:47], v[136:151]
    v_exp_f32 v90, v90
    v_exp_f32 v91, v91
    v_exp_f32 v92, v92
    v_exp_f32 v93, v93
    s_waitcnt vmcnt(4)
    v_mfma_f32_32x32x16_bf16 v[40:55], v[56:59], v[8:11], 0
    v_cvt_pk_bf16_f32 v88, v88, v89
    v_exp_f32 v94, v94
    v_exp_f32 v95, v95
    v_cvt_pk_bf16_f32 v89, v90, v91
    v_exp_f32 v96, v96
    v_exp_f32 v97, v97
    v_mfma_f32_32x32x16_bf16 v[40:55], v[60:63], v[12:15], v[40:55]
    v_cvt_pk_bf16_f32 v90, v92, v93
    v_exp_f32 v98, v98
    v_exp_f32 v99, v99
    v_cvt_pk_bf16_f32 v91, v94, v95
    v_exp_f32 v100, v100
    v_exp_f32 v101, v101
    v_mfma_f32_32x32x16_bf16 v[152:167], v[80:83], v[88:91], v[152:167]
    v_exp_f32 v102, v102
    v_exp_f32 v103, v103
    v_cvt_pk_bf16_f32 v92, v96, v97
    v_cvt_pk_bf16_f32 v93, v98, v99
    v_cvt_pk_bf16_f32 v94, v100, v101
    v_cvt_pk_bf16_f32 v95, v102, v103
    s_setprio 1
    v_exp_f32 v40, v40
    v_exp_f32 v41, v41
    v_mfma_f32_32x32x16_bf16 v[152:167], v[84:87], v[92:95], v[152:167]
    s_add_u32 s89, s81, 5
    s_and_b32 s89, s89, 7
    s_lshl_b32 s89, s89, 12
    s_add_u32 s89, s89, s80
    buffer_load_dwordx4 v[80:83], v2, s[40:43], s89 offen offset:2048 sc1
    buffer_load_dwordx4 v[84:87], v2, s[40:43], s89 offen offset:3072 sc1
    v_exp_f32 v42, v42
    v_exp_f32 v43, v43
    v_exp_f32 v44, v44
    v_exp_f32 v45, v45
    v_mfma_f32_32x32x16_bf16 v[88:103], v[56:59], v[16:19], 0
    v_cvt_pk_bf16_f32 v40, v40, v41
    v_exp_f32 v46, v46
    v_exp_f32 v47, v47
    v_cvt_pk_bf16_f32 v41, v42, v43
    v_exp_f32 v48, v48
    v_exp_f32 v49, v49
    v_mfma_f32_32x32x16_bf16 v[88:103], v[60:63], v[20:23], v[88:103]
    v_cvt_pk_bf16_f32 v42, v44, v45
    v_exp_f32 v50, v50
    v_exp_f32 v51, v51
    v_cvt_pk_bf16_f32 v43, v46, v47
    v_exp_f32 v52, v52
    v_exp_f32 v53, v53
    s_waitcnt vmcnt(4)
    v_mfma_f32_32x32x16_bf16 v[104:119], v[64:67], v[40:43], v[104:119]
    v_exp_f32 v54, v54
    v_exp_f32 v55, v55
    v_cvt_pk_bf16_f32 v44, v48, v49
    v_cvt_pk_bf16_f32 v45, v50, v51
    v_cvt_pk_bf16_f32 v46, v52, v53
    v_cvt_pk_bf16_f32 v47, v54, v55
    v_exp_f32 v88, v88
    v_exp_f32 v89, v89
    v_mfma_f32_32x32x16_bf16 v[104:119], v[68:71], v[44:47], v[104:119]
    v_exp_f32 v90, v90
    v_exp_f32 v91, v91
    v_exp_f32 v92, v92
    v_exp_f32 v93, v93
    v_mfma_f32_32x32x16_bf16 v[40:55], v[56:59], v[24:27], 0
    v_cvt_pk_bf16_f32 v88, v88, v89
    v_exp_f32 v94, v94
    v_exp_f32 v95, v95
    v_cvt_pk_bf16_f32 v89, v90, v91
    v_exp_f32 v96, v96
    v_exp_f32 v97, v97
    v_mfma_f32_32x32x16_bf16 v[40:55], v[60:63], v[28:31], v[40:55]
    v_cvt_pk_bf16_f32 v90, v92, v93
    v_exp_f32 v98, v98
    v_exp_f32 v99, v99
    v_cvt_pk_bf16_f32 v91, v94, v95
    v_exp_f32 v100, v100
    v_exp_f32 v101, v101
    v_mfma_f32_32x32x16_bf16 v[120:135], v[64:67], v[88:91], v[120:135]
    v_exp_f32 v102, v102
    v_exp_f32 v103, v103
    v_cvt_pk_bf16_f32 v92, v96, v97
    v_cvt_pk_bf16_f32 v93, v98, v99
    v_cvt_pk_bf16_f32 v94, v100, v101
    v_cvt_pk_bf16_f32 v95, v102, v103
    v_exp_f32 v40, v40
    v_exp_f32 v41, v41
    v_mfma_f32_32x32x16_bf16 v[120:135], v[68:71], v[92:95], v[120:135]
    v_exp_f32 v42, v42
    v_exp_f32 v43, v43
    v_exp_f32 v44, v44
    v_exp_f32 v45, v45
    v_mfma_f32_32x32x16_bf16 v[88:103], v[56:59], v[32:35], 0
    v_cvt_pk_bf16_f32 v40, v40, v41
    v_exp_f32 v46, v46
    v_exp_f32 v47, v47
    v_cvt_pk_bf16_f32 v41, v42, v43
    v_exp_f32 v48, v48
    v_exp_f32 v49, v49
    v_mfma_f32_32x32x16_bf16 v[88:103], v[60:63], v[36:39], v[88:103]
    s_add_u32 s88, s81, 6
    s_and_b32 s88, s88, 7
    s_lshl_b32 s88, s88, 12
    s_add_u32 s88, s88, s80
    buffer_load_dwordx4 v[56:59], v2, s[40:43], s88 offen sc1
    buffer_load_dwordx4 v[60:63], v2, s[40:43], s88 offen offset:1024 sc1
    v_cvt_pk_bf16_f32 v42, v44, v45
    v_exp_f32 v50, v50
    v_exp_f32 v51, v51
    v_cvt_pk_bf16_f32 v43, v46, v47
    v_exp_f32 v52, v52
    v_exp_f32 v53, v53
    v_mfma_f32_32x32x16_bf16 v[136:151], v[64:67], v[40:43], v[136:151]
    v_exp_f32 v54, v54
    v_exp_f32 v55, v55
    v_cvt_pk_bf16_f32 v44, v48, v49
    v_cvt_pk_bf16_f32 v45, v50, v51
    v_cvt_pk_bf16_f32 v46, v52, v53
    v_cvt_pk_bf16_f32 v47, v54, v55
    v_exp_f32 v88, v88
    v_exp_f32 v89, v89
    v_mfma_f32_32x32x16_bf16 v[136:151], v[68:71], v[44:47], v[136:151]
    v_exp_f32 v90, v90
    v_exp_f32 v91, v91
    v_exp_f32 v92, v92
    v_exp_f32 v93, v93
    s_waitcnt vmcnt(4)
    v_mfma_f32_32x32x16_bf16 v[40:55], v[72:75], v[8:11], 0
    v_cvt_pk_bf16_f32 v88, v88, v89
    v_exp_f32 v94, v94
    v_exp_f32 v95, v95
    v_cvt_pk_bf16_f32 v89, v90, v91
    v_exp_f32 v96, v96
    v_exp_f32 v97, v97
    v_mfma_f32_32x32x16_bf16 v[40:55], v[76:79], v[12:15], v[40:55]
    v_cvt_pk_bf16_f32 v90, v92, v93
    v_exp_f32 v98, v98
    v_exp_f32 v99, v99
    v_cvt_pk_bf16_f32 v91, v94, v95
    v_exp_f32 v100, v100
    v_exp_f32 v101, v101
    v_mfma_f32_32x32x16_bf16 v[152:167], v[64:67], v[88:91], v[152:167]
    v_exp_f32 v102, v102
    v_exp_f32 v103, v103
    v_cvt_pk_bf16_f32 v92, v96, v97
    v_cvt_pk_bf16_f32 v93, v98, v99
    v_cvt_pk_bf16_f32 v94, v100, v101
    v_cvt_pk_bf16_f32 v95, v102, v103
    v_exp_f32 v40, v40
    v_exp_f32 v41, v41
    v_mfma_f32_32x32x16_bf16 v[152:167], v[68:71], v[92:95], v[152:167]
    s_add_u32 s89, s81, 6
    s_and_b32 s89, s89, 7
    s_lshl_b32 s89, s89, 12
    s_add_u32 s89, s89, s80
    buffer_load_dwordx4 v[64:67], v2, s[40:43], s89 offen offset:2048 sc1
    buffer_load_dwordx4 v[68:71], v2, s[40:43], s89 offen offset:3072 sc1
    v_exp_f32 v42, v42
    v_exp_f32 v43, v43
    v_exp_f32 v44, v44
    v_exp_f32 v45, v45
    v_mfma_f32_32x32x16_bf16 v[88:103], v[72:75], v[16:19], 0
    v_cvt_pk_bf16_f32 v40, v40, v41
    v_exp_f32 v46, v46
    v_exp_f32 v47, v47
    v_cvt_pk_bf16_f32 v41, v42, v43
    v_exp_f32 v48, v48
    v_exp_f32 v49, v49
    v_mfma_f32_32x32x16_bf16 v[88:103], v[76:79], v[20:23], v[88:103]
    v_cvt_pk_bf16_f32 v42, v44, v45
    v_exp_f32 v50, v50
    v_exp_f32 v51, v51
    v_cvt_pk_bf16_f32 v43, v46, v47
    v_exp_f32 v52, v52
    v_exp_f32 v53, v53
    s_waitcnt vmcnt(4)
    v_mfma_f32_32x32x16_bf16 v[104:119], v[80:83], v[40:43], v[104:119]
    v_exp_f32 v54, v54
    v_exp_f32 v55, v55
    v_cvt_pk_bf16_f32 v44, v48, v49
    v_cvt_pk_bf16_f32 v45, v50, v51
    v_cvt_pk_bf16_f32 v46, v52, v53
    v_cvt_pk_bf16_f32 v47, v54, v55
    v_exp_f32 v88, v88
    v_exp_f32 v89, v89
    v_mfma_f32_32x32x16_bf16 v[104:119], v[84:87], v[44:47], v[104:119]
    v_exp_f32 v90, v90
    v_exp_f32 v91, v91
    v_exp_f32 v92, v92
    v_exp_f32 v93, v93
    v_mfma_f32_32x32x16_bf16 v[40:55], v[72:75], v[24:27], 0
    v_cvt_pk_bf16_f32 v88, v88, v89
    v_exp_f32 v94, v94
    v_exp_f32 v95, v95
    v_cvt_pk_bf16_f32 v89, v90, v91
    v_exp_f32 v96, v96
    v_exp_f32 v97, v97
    v_mfma_f32_32x32x16_bf16 v[40:55], v[76:79], v[28:31], v[40:55]
    v_cvt_pk_bf16_f32 v90, v92, v93
    v_exp_f32 v98, v98
    v_exp_f32 v99, v99
    v_cvt_pk_bf16_f32 v91, v94, v95
    v_exp_f32 v100, v100
    v_exp_f32 v101, v101
    v_mfma_f32_32x32x16_bf16 v[120:135], v[80:83], v[88:91], v[120:135]
    v_exp_f32 v102, v102
    v_exp_f32 v103, v103
    v_cvt_pk_bf16_f32 v92, v96, v97
    v_cvt_pk_bf16_f32 v93, v98, v99
    v_cvt_pk_bf16_f32 v94, v100, v101
    v_cvt_pk_bf16_f32 v95, v102, v103
    v_exp_f32 v40, v40
    v_exp_f32 v41, v41
    v_mfma_f32_32x32x16_bf16 v[120:135], v[84:87], v[92:95], v[120:135]
    v_exp_f32 v42, v42
    v_exp_f32 v43, v43
    v_exp_f32 v44, v44
    v_exp_f32 v45, v45
    v_mfma_f32_32x32x16_bf16 v[88:103], v[72:75], v[32:35], 0
    v_cvt_pk_bf16_f32 v40, v40, v41
    v_exp_f32 v46, v46
    v_exp_f32 v47, v47
    v_cvt_pk_bf16_f32 v41, v42, v43
    v_exp_f32 v48, v48
    v_exp_f32 v49, v49
    v_mfma_f32_32x32x16_bf16 v[88:103], v[76:79], v[36:39], v[88:103]
    s_add_u32 s88, s81, 7
    s_and_b32 s88, s88, 7
    s_lshl_b32 s88, s88, 12
    s_add_u32 s88, s88, s80
    buffer_load_dwordx4 v[72:75], v2, s[40:43], s88 offen sc1
    buffer_load_dwordx4 v[76:79], v2, s[40:43], s88 offen offset:1024 sc1
    v_cvt_pk_bf16_f32 v42, v44, v45
    v_exp_f32 v50, v50
    v_exp_f32 v51, v51
    v_cvt_pk_bf16_f32 v43, v46, v47
    v_exp_f32 v52, v52
    v_exp_f32 v53, v53
    v_mfma_f32_32x32x16_bf16 v[136:151], v[80:83], v[40:43], v[136:151]
    v_exp_f32 v54, v54
    v_exp_f32 v55, v55
    v_cvt_pk_bf16_f32 v44, v48, v49
    v_cvt_pk_bf16_f32 v45, v50, v51
    v_cvt_pk_bf16_f32 v46, v52, v53
    v_cvt_pk_bf16_f32 v47, v54, v55
    v_exp_f32 v88, v88
    v_exp_f32 v89, v89
    v_mfma_f32_32x32x16_bf16 v[136:151], v[84:87], v[44:47], v[136:151]
    v_exp_f32 v90, v90
    v_exp_f32 v91, v91
    v_exp_f32 v92, v92
    v_exp_f32 v93, v93
    s_waitcnt vmcnt(4)
    v_mfma_f32_32x32x16_bf16 v[40:55], v[56:59], v[8:11], 0
    v_cvt_pk_bf16_f32 v88, v88, v89
    v_exp_f32 v94, v94
    v_exp_f32 v95, v95
    v_cvt_pk_bf16_f32 v89, v90, v91
    v_exp_f32 v96, v96
    v_exp_f32 v97, v97
    v_mfma_f32_32x32x16_bf16 v[40:55], v[60:63], v[12:15], v[40:55]
    v_cvt_pk_bf16_f32 v90, v92, v93
    v_exp_f32 v98, v98
    v_exp_f32 v99, v99
    v_cvt_pk_bf16_f32 v91, v94, v95
    v_exp_f32 v100, v100
    v_exp_f32 v101, v101
    v_mfma_f32_32x32x16_bf16 v[152:167], v[80:83], v[88:91], v[152:167]
    v_exp_f32 v102, v102
    v_exp_f32 v103, v103
    v_cvt_pk_bf16_f32 v92, v96, v97
    v_cvt_pk_bf16_f32 v93, v98, v99
    v_cvt_pk_bf16_f32 v94, v100, v101
    v_cvt_pk_bf16_f32 v95, v102, v103
    s_setprio 0
    v_exp_f32 v40, v40
    v_exp_f32 v41, v41
    v_mfma_f32_32x32x16_bf16 v[152:167], v[84:87], v[92:95], v[152:167]
    s_add_u32 s89, s81, 7
    s_and_b32 s89, s89, 7
    s_lshl_b32 s89, s89, 12
    s_add_u32 s89, s89, s80
    buffer_load_dwordx4 v[80:83], v2, s[40:43], s89 offen offset:2048 sc1
    buffer_load_dwordx4 v[84:87], v2, s[40:43], s89 offen offset:3072 sc1
    v_exp_f32 v42, v42
    v_exp_f32 v43, v43
    v_exp_f32 v44, v44
    v_exp_f32 v45, v45
    v_mfma_f32_32x32x16_bf16 v[88:103], v[56:59], v[16:19], 0
    v_cvt_pk_bf16_f32 v40, v40, v41
    v_exp_f32 v46, v46
    v_exp_f32 v47, v47
    v_cvt_pk_bf16_f32 v41, v42, v43
    v_exp_f32 v48, v48
    v_exp_f32 v49, v49
    v_mfma_f32_32x32x16_bf16 v[88:103], v[60:63], v[20:23], v[88:103]
    v_cvt_pk_bf16_f32 v42, v44, v45
    v_exp_f32 v50, v50
    v_exp_f32 v51, v51
    v_cvt_pk_bf16_f32 v43, v46, v47
    v_exp_f32 v52, v52
    v_exp_f32 v53, v53
    s_waitcnt vmcnt(4)
    v_mfma_f32_32x32x16_bf16 v[104:119], v[64:67], v[40:43], v[104:119]
    v_exp_f32 v54, v54
    v_exp_f32 v55, v55
    v_cvt_pk_bf16_f32 v44, v48, v49
    v_cvt_pk_bf16_f32 v45, v50, v51
    v_cvt_pk_bf16_f32 v46, v52, v53
    v_cvt_pk_bf16_f32 v47, v54, v55
    v_exp_f32 v88, v88
    v_exp_f32 v89, v89
    v_mfma_f32_32x32x16_bf16 v[104:119], v[68:71], v[44:47], v[104:119]
    v_exp_f32 v90, v90
    v_exp_f32 v91, v91
    v_exp_f32 v92, v92
    v_exp_f32 v93, v93
    s_waitcnt vmcnt(2)
    v_mfma_f32_32x32x16_bf16 v[40:55], v[72:75], v[8:11], 0
    v_cvt_pk_bf16_f32 v88, v88, v89
    v_exp_f32 v94, v94
    v_exp_f32 v95, v95
    v_cvt_pk_bf16_f32 v89, v90, v91
    v_exp_f32 v96, v96
    v_exp_f32 v97, v97
    v_mfma_f32_32x32x16_bf16 v[40:55], v[76:79], v[12:15], v[40:55]
    v_cvt_pk_bf16_f32 v90, v92, v93
    v_exp_f32 v98, v98
    v_exp_f32 v99, v99
    v_cvt_pk_bf16_f32 v91, v94, v95
    v_exp_f32 v100, v100
    v_exp_f32 v101, v101
    v_mfma_f32_32x32x16_bf16 v[120:135], v[64:67], v[88:91], v[120:135]
    v_exp_f32 v102, v102
    v_exp_f32 v103, v103
    v_cvt_pk_bf16_f32 v92, v96, v97
    v_cvt_pk_bf16_f32 v93, v98, v99
    v_cvt_pk_bf16_f32 v94, v100, v101
    v_cvt_pk_bf16_f32 v95, v102, v103
    v_exp_f32 v40, v40
    v_exp_f32 v41, v41
    v_mfma_f32_32x32x16_bf16 v[120:135], v[68:71], v[92:95], v[120:135]
    v_exp_f32 v42, v42
    v_exp_f32 v43, v43
    v_exp_f32 v44, v44
    v_exp_f32 v45, v45
    v_mfma_f32_32x32x16_bf16 v[88:103], v[72:75], v[16:19], 0
    v_cvt_pk_bf16_f32 v40, v40, v41
    v_exp_f32 v46, v46
    v_exp_f32 v47, v47
    v_cvt_pk_bf16_f32 v41, v42, v43
    v_exp_f32 v48, v48
    v_exp_f32 v49, v49
    v_mfma_f32_32x32x16_bf16 v[88:103], v[76:79], v[20:23], v[88:103]
    v_cvt_pk_bf16_f32 v42, v44, v45
    v_exp_f32 v50, v50
    v_exp_f32 v51, v51
    v_cvt_pk_bf16_f32 v43, v46, v47
    v_exp_f32 v52, v52
    v_exp_f32 v53, v53
    s_waitcnt vmcnt(0)
    v_mfma_f32_32x32x16_bf16 v[104:119], v[80:83], v[40:43], v[104:119]
    v_exp_f32 v54, v54
    v_exp_f32 v55, v55
    v_cvt_pk_bf16_f32 v44, v48, v49
    v_cvt_pk_bf16_f32 v45, v50, v51
    v_cvt_pk_bf16_f32 v46, v52, v53
    v_cvt_pk_bf16_f32 v47, v54, v55
    v_exp_f32 v88, v88
    v_exp_f32 v89, v89
    v_mfma_f32_32x32x16_bf16 v[104:119], v[84:87], v[44:47], v[104:119]
    v_exp_f32 v90, v90
    v_exp_f32 v91, v91
    v_exp_f32 v92, v92
    v_exp_f32 v93, v93
    v_mfma_f32_32x32x16_bf16 v[40:55], v[56:59], v[24:27], 0
    v_cvt_pk_bf16_f32 v88, v88, v89
    v_exp_f32 v94, v94
    v_exp_f32 v95, v95
    v_cvt_pk_bf16_f32 v89, v90, v91
    v_exp_f32 v96, v96
    v_exp_f32 v97, v97
    v_mfma_f32_32x32x16_bf16 v[40:55], v[60:63], v[28:31], v[40:55]
    v_cvt_pk_bf16_f32 v90, v92, v93
    v_exp_f32 v98, v98
    v_exp_f32 v99, v99
    v_cvt_pk_bf16_f32 v91, v94, v95
    v_exp_f32 v100, v100
    v_exp_f32 v101, v101
    v_mfma_f32_32x32x16_bf16 v[120:135], v[80:83], v[88:91], v[120:135]
    v_exp_f32 v102, v102
    v_exp_f32 v103, v103
    v_cvt_pk_bf16_f32 v92, v96, v97
    v_cvt_pk_bf16_f32 v93, v98, v99
    v_cvt_pk_bf16_f32 v94, v100, v101
    v_cvt_pk_bf16_f32 v95, v102, v103
    v_mov_b32 v4, 162920
    s_mov_b32 s69, 0
L_sp_38:
    ds_read_b32 v5, v4
    s_add_u32 s69, s69, 1
    s_waitcnt lgkmcnt(0)
    v_readfirstlane_b32 s68, v5
    s_nop 0
    s_cmp_ge_u32 s68, 4
    s_cbranch_scc1 L_spd_39
    s_cmp_gt_u32 s69, 1048576
    s_cbranch_scc1 L_spd_39
    s_sleep 1
    s_branch L_sp_38
L_spd_39:
    ds_write_b128 v3, v[104:107] offset:0
    ds_write_b128 v3, v[108:111] offset:1024
    ds_write_b128 v3, v[112:115] offset:2048
    ds_write_b128 v3, v[116:119] offset:3072
    s_mov_b32 exec_lo, 0
    ds_write_b32 v7, v116 offset:0
    s_mov_b64 exec, -1
    v_exp_f32 v40, v40
    v_exp_f32 v41, v41
    v_mfma_f32_32x32x16_bf16 v[120:135], v[84:87], v[92:95], v[120:135]
    v_exp_f32 v42, v42
    v_exp_f32 v43, v43
    v_exp_f32 v44, v44
    v_exp_f32 v45, v45
    v_mfma_f32_32x32x16_bf16 v[88:103], v[72:75], v[24:27], 0
    v_cvt_pk_bf16_f32 v40, v40, v41
    v_exp_f32 v46, v46
    v_exp_f32 v47, v47
    v_cvt_pk_bf16_f32 v41, v42, v43
    v_exp_f32 v48, v48
    v_exp_f32 v49, v49
    v_mfma_f32_32x32x16_bf16 v[88:103], v[76:79], v[28:31], v[88:103]
    v_cvt_pk_bf16_f32 v42, v44, v45
    v_exp_f32 v50, v50
    v_exp_f32 v51, v51
    v_cvt_pk_bf16_f32 v43, v46, v47
    v_exp_f32 v52, v52
    v_exp_f32 v53, v53
    v_mfma_f32_32x32x16_bf16 v[136:151], v[64:67], v[40:43], v[136:151]
    v_exp_f32 v54, v54
    v_exp_f32 v55, v55
    v_cvt_pk_bf16_f32 v44, v48, v49
    v_cvt_pk_bf16_f32 v45, v50, v51
    v_cvt_pk_bf16_f32 v46, v52, v53
    v_cvt_pk_bf16_f32 v47, v54, v55
    ds_write_b128 v3, v[120:123] offset:4096
    ds_write_b128 v3, v[124:127] offset:5120
    ds_write_b128 v3, v[128:131] offset:6144
    ds_write_b128 v3, v[132:135] offset:7168
    s_mov_b32 exec_lo, 0
    ds_write_b32 v7, v132 offset:1024
    s_mov_b64 exec, -1
    v_exp_f32 v88, v88
    v_exp_f32 v89, v89
    v_mfma_f32_32x32x16_bf16 v[136:151], v[68:71], v[44:47], v[136:151]
    v_exp_f32 v90, v90
    v_exp_f32 v91, v91
    v_exp_f32 v92, v92
    v_exp_f32 v93, v93
    v_mfma_f32_32x32x16_bf16 v[40:55], v[56:59], v[32:35], 0
    v_cvt_pk_bf16_f32 v88, v88, v89
    v_exp_f32 v94, v94
    v_exp_f32 v95, v95
    v_cvt_pk_bf16_f32 v89, v90, v91
    v_exp_f32 v96, v96
    v_exp_f32 v97, v97
    v_mfma_f32_32x32x16_bf16 v[40:55], v[60:63], v[36:39], v[40:55]
    v_cvt_pk_bf16_f32 v90, v92, v93
    v_exp_f32 v98, v98
    v_exp_f32 v99, v99
    v_cvt_pk_bf16_f32 v91, v94, v95
    v_exp_f32 v100, v100
    v_exp_f32 v101, v101
    v_mfma_f32_32x32x16_bf16 v[136:151], v[80:83], v[88:91], v[136:151]
    v_exp_f32 v102, v102
    v_exp_f32 v103, v103
    v_cvt_pk_bf16_f32 v92, v96, v97
    v_cvt_pk_bf16_f32 v93, v98, v99
    v_cvt_pk_bf16_f32 v94, v100, v101
    v_cvt_pk_bf16_f32 v95, v102, v103
    v_exp_f32 v40, v40
    v_exp_f32 v41, v41
    v_mfma_f32_32x32x16_bf16 v[136:151], v[84:87], v[92:95], v[136:151]
    v_exp_f32 v42, v42
    v_exp_f32 v43, v43
    v_exp_f32 v44, v44
    v_exp_f32 v45, v45
    v_mfma_f32_32x32x16_bf16 v[88:103], v[72:75], v[32:35], 0
    v_cvt_pk_bf16_f32 v40, v40, v41
    v_exp_f32 v46, v46
    v_exp_f32 v47, v47
    v_cvt_pk_bf16_f32 v41, v42, v43
    v_exp_f32 v48, v48
    v_exp_f32 v49, v49
    v_mfma_f32_32x32x16_bf16 v[88:103], v[76:79], v[36:39], v[88:103]
    v_cvt_pk_bf16_f32 v42, v44, v45
    v_exp_f32 v50, v50
    v_exp_f32 v51, v51
    v_cvt_pk_bf16_f32 v43, v46, v47
    v_exp_f32 v52, v52
    v_exp_f32 v53, v53
    v_mfma_f32_32x32x16_bf16 v[152:167], v[64:67], v[40:43], v[152:167]
    v_exp_f32 v54, v54
    v_exp_f32 v55, v55
    v_cvt_pk_bf16_f32 v44, v48, v49
    v_cvt_pk_bf16_f32 v45, v50, v51
    v_cvt_pk_bf16_f32 v46, v52, v53
    v_cvt_pk_bf16_f32 v47, v54, v55
    ds_write_b128 v3, v[136:139] offset:8192
    ds_write_b128 v3, v[140:143] offset:9216
    ds_write_b128 v3, v[144:147] offset:10240
    ds_write_b128 v3, v[148:151] offset:11264
    s_mov_b32 exec_lo, 0
    ds_write_b32 v7, v148 offset:2048
    s_mov_b64 exec, -1
    v_exp_f32 v88, v88
    v_exp_f32 v89, v89
    v_mfma_f32_32x32x16_bf16 v[152:167], v[68:71], v[44:47], v[152:167]
    v_exp_f32 v90, v90
    v_exp_f32 v91, v91
    v_exp_f32 v92, v92
    v_exp_f32 v93, v93
    v_cvt_pk_bf16_f32 v88, v88, v89
    v_exp_f32 v94, v94
    v_exp_f32 v95, v95
    v_cvt_pk_bf16_f32 v89, v90, v91
    v_exp_f32 v96, v96
    v_exp_f32 v97, v97
    v_cvt_pk_bf16_f32 v90, v92, v93
    v_exp_f32 v98, v98
    v_exp_f32 v99, v99
    v_cvt_pk_bf16_f32 v91, v94, v95
    v_exp_f32 v100, v100
    v_exp_f32 v101, v101
    v_mfma_f32_32x32x16_bf16 v[152:167], v[80:83], v[88:91], v[152:167]
    v_exp_f32 v102, v102
    v_exp_f32 v103, v103
    v_cvt_pk_bf16_f32 v92, v96, v97
    v_cvt_pk_bf16_f32 v93, v98, v99
    v_cvt_pk_bf16_f32 v94, v100, v101
    v_cvt_pk_bf16_f32 v95, v102, v103
    s_nop 1
    v_mfma_f32_32x32x16_bf16 v[152:167], v[84:87], v[92:95], v[152:167]
    s_nop 11
    ds_write_b128 v3, v[152:155] offset:12288
    ds_write_b128 v3, v[156:159] offset:13312
    ds_write_b128 v3, v[160:163] offset:14336
    ds_write_b128 v3, v[164:167] offset:15360
    s_mov_b32 exec_lo, 0
    ds_write_b32 v7, v164 offset:3072
    s_mov_b64 exec, -1
    s_setprio 3
    s_lshr_b32 s92, s3, 1
    s_and_b32 s93, s3, 1
    s_lshl_b32 s68, s92, 12
    s_lshl_b32 s69, s93, 11
    s_add_u32 s69, s69, s68
    v_add_u32 v8, s69, v2
    v_add_u32 v9, 0x10000, v8
    v_and_b32 v10, 31, v1
    v_lshlrev_b32 v10, 5, v10
    s_lshl_b32 s68, s92, 10
    s_add_u32 s68, s68, 151552
    v_add_u32 v10, s68, v10
    s_lshl_b32 s91, s5, 2
    s_add_u32 s91, s91, s92
    s_lshl_b32 s91, s91, 4
    s_add_u32 s91, s91, s4
    s_lshl_b32 s91, s91, 1
    s_add_u32 s91, s91, s93
    s_lshl_b32 s91, s91, 10
    s_add_u32 s91, s91, 12582912
    s_mov_b32 s90, 0
    s_cmp_eq_u32 s93, 1
    s_cselect_b32 s90, -1, 0
    s_waitcnt lgkmcnt(0)
    s_mov_b64 exec, 1
    v_mov_b32 v4, 162828
    v_mov_b32 v5, 1
    ds_add_u32 v4, v5
    s_mov_b64 exec, -1
    v_mov_b32 v4, 162828
    s_mov_b32 s69, 0
L_sp_40:
    ds_read_b32 v5, v4
    s_add_u32 s69, s69, 1
    s_waitcnt lgkmcnt(0)
    v_readfirstlane_b32 s68, v5
    s_nop 0
    s_cmp_ge_u32 s68, s84
    s_cbranch_scc1 L_spd_41
    s_cmp_gt_u32 s69, 1048576
    s_cbranch_scc1 L_spd_41
    s_sleep 1
    s_branch L_sp_40
L_spd_41:
    ds_read_b128 v[40:43], v10
    ds_read_b128 v[44:47], v10 offset:16
    ds_read_b128 v[104:107], v8 offset:0
    ds_read_b128 v[108:111], v8 offset:1024
    ds_read_b128 v[112:115], v8 offset:16384
    ds_read_b128 v[116:119], v8 offset:17408
    ds_read_b128 v[120:123], v8 offset:32768
    ds_read_b128 v[124:127], v8 offset:33792
    ds_read_b128 v[128:131], v8 offset:49152
    ds_read_b128 v[132:135], v8 offset:50176
    ds_read_b128 v[136:139], v9 offset:0
    ds_read_b128 v[140:143], v9 offset:1024
    ds_read_b128 v[144:147], v9 offset:16384
    ds_read_b128 v[148:151], v9 offset:17408
    ds_read_b128 v[152:155], v9 offset:32768
    ds_read_b128 v[156:159], v9 offset:33792
    ds_read_b128 v[160:163], v9 offset:49152
    ds_read_b128 v[164:167], v9 offset:50176
    s_add_u32 s84, s84, 8
    s_waitcnt lgkmcnt(12)
    v_pk_add_f32 v[40:41], v[40:41], v[42:43]
    v_pk_add_f32 v[44:45], v[44:45], v[46:47]
    v_pk_add_f32 v[40:41], v[40:41], v[44:45]
    v_add_f32 v40, v40, v41
    v_rcp_f32 v41, v40
    s_waitcnt lgkmcnt(12)
    v_pk_add_f32 v[104:105], v[104:105], v[112:113]
    v_pk_add_f32 v[106:107], v[106:107], v[114:115]
    v_pk_add_f32 v[108:109], v[108:109], v[116:117]
    v_pk_add_f32 v[110:111], v[110:111], v[118:119]
    s_waitcnt lgkmcnt(10)
    v_pk_add_f32 v[104:105], v[104:105], v[120:121]
    v_pk_add_f32 v[106:107], v[106:107], v[122:123]
    v_pk_add_f32 v[108:109], v[108:109], v[124:125]
    v_pk_add_f32 v[110:111], v[110:111], v[126:127]
    s_waitcnt lgkmcnt(8)
    v_pk_add_f32 v[104:105], v[104:105], v[128:129]
    v_pk_add_f32 v[106:107], v[106:107], v[130:131]
    v_pk_add_f32 v[108:109], v[108:109], v[132:133]
    v_pk_add_f32 v[110:111], v[110:111], v[134:135]
    s_waitcnt lgkmcnt(6)
    v_pk_add_f32 v[104:105], v[104:105], v[136:137]
    v_pk_add_f32 v[106:107], v[106:107], v[138:139]
    v_pk_add_f32 v[108:109], v[108:109], v[140:141]
    v_pk_add_f32 v[110:111], v[110:111], v[142:143]
    s_waitcnt lgkmcnt(4)
    v_pk_add_f32 v[104:105], v[104:105], v[144:145]
    v_pk_add_f32 v[106:107], v[106:107], v[146:147]
    v_pk_add_f32 v[108:109], v[108:109], v[148:149]
    v_pk_add_f32 v[110:111], v[110:111], v[150:151]
    s_waitcnt lgkmcnt(2)
    v_pk_add_f32 v[104:105], v[104:105], v[152:153]
    v_pk_add_f32 v[106:107], v[106:107], v[154:155]
    v_pk_add_f32 v[108:109], v[108:109], v[156:157]
    v_pk_add_f32 v[110:111], v[110:111], v[158:159]
    s_waitcnt lgkmcnt(0)
    v_pk_add_f32 v[104:105], v[104:105], v[160:161]
    v_pk_add_f32 v[106:107], v[106:107], v[162:163]
    v_pk_add_f32 v[108:109], v[108:109], v[164:165]
    v_pk_add_f32 v[110:111], v[110:111], v[166:167]
    v_mul_f32 v104, v104, v41
    v_mul_f32 v105, v105, v41
    v_mul_f32 v106, v106, v41
    v_mul_f32 v107, v107, v41
    v_mul_f32 v108, v108, v41
    v_mul_f32 v109, v109, v41
    v_mul_f32 v110, v110, v41
    v_mul_f32 v111, v111, v41
    v_cvt_pk_bf16_f32 v44, v104, v105
    v_cvt_pk_bf16_f32 v45, v106, v107
    v_cvt_pk_bf16_f32 v46, v108, v109
    v_cvt_pk_bf16_f32 v47, v110, v111
    s_mov_b32 exec_lo, 0
    s_mov_b32 exec_hi, s90
    v_mov_b32 v46, 0
    v_mov_b32 v47, 0
    s_mov_b64 exec, -1
    buffer_store_dwordx4 v[44:47], v2, s[40:43], s91 offen sc1
    s_mov_b32 s94, 0x71800000
    s_movk_i32 s95, 0x207
    v_cmp_nlt_f32 s[76:77], v40, s94
    s_mov_b32 s94, 0x12800000
    v_cmp_nle_f32 vcc, s94, v40
    s_nop 0
    s_or_b64 s[76:77], s[76:77], vcc
    v_add_f32 v42, v104, v105
    v_add_f32 v43, v106, v107
    v_add_f32 v104, v108, v109
    v_add_f32 v105, v110, v111
    v_add_f32 v42, v42, v43
    v_add_f32 v104, v104, v105
    v_add_f32 v42, v42, v104
    v_cmp_class_f32_e64 vcc, v42, s95
    s_nop 0
    s_or_b64 s[76:77], s[76:77], vcc
    s_cmp_eq_u64 s[76:77], 0
    s_cselect_b32 s94, 1, 0x10001
    s_waitcnt vmcnt(0)
    s_mov_b64 exec, 1
    v_mov_b32 v4, 162832
    v_mov_b32 v5, s94
    ds_add_rtn_u32 v5, v4, v5
    s_waitcnt lgkmcnt(0)
    v_readfirstlane_b32 s68, v5
    s_nop 0
    s_add_u32 s68, s68, s94
    s_and_b32 s69, s68, 0xffff
    s_cmp_eq_u32 s69, s85
    s_cbranch_scc0 L_np_42
    s_lshr_b32 s69, s68, 16
    s_cmp_eq_u32 s69, s86
    s_cbranch_scc1 L_dopub_45
    s_cmp_eq_u32 s82, 0
    s_cbranch_scc1 L_np_42
L_dopub_45:
    s_lshl_b32 s68, s4, 4
    s_add_u32 s68, s68, s5
    s_lshl_b32 s68, s68, 7
    s_add_u32 s68, s68, 65536
    v_mov_b32 v6, s68
    v_mov_b32 v4, s44
    v_mov_b32 v5, s45
    buffer_store_dwordx2 v[4:5], v6, s[40:43], 0 offen sc1
    s_mov_b64 exec, -1
    s_branch L_main_exit
L_np_42:
    v_mov_b32 v4, 162832
    s_mov_b32 s70, 0
L_sp_43:
    ds_read_b32 v5, v4
    s_add_u32 s70, s70, 1
    s_waitcnt lgkmcnt(0)
    v_readfirstlane_b32 s68, v5
    s_nop 0
    s_and_b32 s69, s68, 0xffff
    s_cmp_ge_u32 s69, s85
    s_cbranch_scc1 L_ok_44
    s_cmp_gt_u32 s70, 1048576
    s_cbranch_scc0 L_sp_43
L_ok_44:
    s_mov_b64 exec, -1
    s_lshr_b32 s69, s68, 16
    s_cmp_eq_u32 s69, s86
    s_cbranch_scc1 L_main_exit
    s_cmp_eq_u32 s82, 0
    s_cbranch_scc0 L_main_exit
    s_mov_b32 s82, 1
    s_mov_b32 s86, s69
    s_add_u32 s85, s85, 8
    s_branch L_attn_retry
L_main_exit:
    s_mov_b64 exec, 1
    v_mov_b32 v4, 162904
    v_mov_b32 v5, 1
    ds_add_u32 v4, v5
    s_mov_b64 exec, -1
    s_cmp_eq_u32 s3, 0
    s_cbranch_scc0 L_opx_46
    s_lshr_b32 s68, s2, 3
    s_cmp_ge_u32 s68, 28
    s_cbranch_scc1 L_opx_46
    s_setprio 0
    s_mul_i32 s69, s68, 37
    s_lshr_b32 s69, s69, 8
    s_and_b32 s70, s2, 7
    s_lshl_b32 s70, s70, 2
    s_add_u32 s70, s70, s69
    s_lshr_b32 s70, s70, 1
    s_mov_b64 exec, 0xffff
    v_lshlrev_b32 v3, 4, v1
    v_add_u32 v3, s70, v3
    v_lshlrev_b32 v3, 7, v3
    v_add_u32 v3, 65536, v3
    v_mov_b32 v6, 162900
    s_mov_b32 s71, 0
L_opl_47:
    buffer_load_dwordx2 v[4:5], v3, s[40:43], 0 offen sc1
    s_add_u32 s71, s71, 1
    s_waitcnt vmcnt(0)
    v_cmp_eq_u32 vcc, s44, v4
    v_cmp_eq_u32 s[72:73], s45, v5
    s_nop 0
    s_and_b64 vcc, vcc, s[72:73]
    s_cmp_gt_u32 s71, 20480
    s_cselect_b32 vcc_lo, 0xffff, vcc_lo
    v_mov_b32 v7, vcc_lo
    ds_write_b32 v6, v7
    s_cmp_eq_u32 vcc_lo, 0xffff
    s_cbranch_scc1 L_opx_46
    s_sleep 1
    s_branch L_opl_47
L_opx_46:
    s_mov_b64 exec, -1
    s_endpgm
L_aux:
    s_sub_u32 s6, s3, 8
    v_lshrrev_b32 v2, 2, v1
    v_and_b32 v3, 3, v1
    v_lshlrev_b32 v3, 4, v3
    v_mul_u32_u24 v4, 2688, v2
    v_add_u32 v4, v4, v3
    v_mul_u32_u24 v5, 3584, v2
    v_add_u32 v5, v5, v3
    v_lshrrev_b32 v2, 3, v1
    v_bfe_u32 v3, v1, 4, 1
    v_lshlrev_b32 v3, 2, v3
    v_and_b32 v7, 7, v1
    v_xor_b32 v3, v3, v7
    v_lshlrev_b32 v3, 4, v3
    v_mul_u32_u24 v8, 3584, v2
    v_add_u32 v8, v8, v3
    s_mul_i32 s83, s4, 56
    s_add_u32 s84, s83, 896
    s_add_u32 s85, s83, 1792
    s_waitcnt lgkmcnt(0)
    s_mov_b32 s12, s50
    s_mov_b32 s13, s51
    s_mov_b32 s14, 1204224
    s_mov_b32 s15, 0x00020000
    s_cmp_eq_u32 s6, 0
    s_cbranch_scc0 L_48
    v_lshlrev_b32 v2, 2, v1
    v_add_u32 v2, 162816, v2
    v_mov_b32 v3, 0
    ds_write_b32 v2, v3
    s_waitcnt lgkmcnt(0)
L_48:
    s_mov_b32 s16, s52
    s_mov_b32 s17, s53
    s_mov_b32 s18, 401408
    s_mov_b32 s19, 0x00020000
    s_mov_b32 s28, s60
    s_mov_b32 s29, s61
    s_mov_b32 s30, 1605632
    s_mov_b32 s31, 0x00020000
    s_barrier
    v_mul_u32_u24 v6, 896, v1
    s_lshl_b32 s88, s2, 2
    s_add_u32 s88, s88, s6
    s_min_u32 s90, s88, 1007
    s_mul_i32 s89, s90, 7282
    s_lshr_b32 s89, s89, 20
    s_mul_i32 s91, s89, 144
    s_sub_u32 s90, s90, s91
    s_lshl_b32 s92, s89, 7
    s_cmp_lt_u32 s90, 112
    s_cbranch_scc0 L_49
    s_mul_i32 s93, s90, 14336
    s_add_u32 s93, s93, s92
    s_add_u32 s94, s93, 7168
    s_mov_b64 exec, 0xffff
    buffer_load_dword v52, v6, s[28:31], s93 offen
    s_mov_b64 exec, -1
    s_branch L_50
L_49:
    s_sub_u32 s93, s90, 112
    s_lshr_b32 s94, s93, 1
    s_mul_i32 s94, s94, 28
    s_and_b32 s93, s93, 1
    s_lshl_b32 s93, s93, 4
    s_add_u32 s93, s93, s94
    s_mul_i32 s93, s93, 896
    s_add_u32 s93, s93, s92
    s_add_u32 s94, s93, 7168
    s_mov_b64 exec, 0xffff
    buffer_load_dword v52, v6, s[16:19], s93 offen
    s_mov_b64 exec, -1
L_50:
    s_mul_i32 s79, s5, 28
    s_lshr_b32 s79, s79, 4
    s_add_u32 s79, s79, s6
    s_cmp_ge_u32 s79, 28
    s_cselect_b32 s80, 28, 0
    s_sub_u32 s79, s79, s80
    s_add_u32 s80, s79, 0
    s_mul_i32 s80, s80, 43008
    s_add_u32 s80, s80, s84
    s_mul_i32 s81, s79, 1024
    s_add_u32 s81, s81, 114688
    s_mov_b32 m0, s81
    s_add_u32 s79, s79, 4
    buffer_load_dwordx4 v4, s[12:15], s80 offen lds
    s_cmp_ge_u32 s79, 28
    s_cselect_b32 s80, 28, 0
    s_sub_u32 s79, s79, s80
    s_add_u32 s80, s79, 0
    s_mul_i32 s80, s80, 43008
    s_add_u32 s80, s80, s84
    s_mul_i32 s81, s79, 1024
    s_add_u32 s81, s81, 114688
    s_mov_b32 m0, s81
    s_add_u32 s79, s79, 4
    buffer_load_dwordx4 v4, s[12:15], s80 offen lds
    s_cmp_ge_u32 s79, 28
    s_cselect_b32 s80, 28, 0
    s_sub_u32 s79, s79, s80
    s_add_u32 s80, s79, 0
    s_mul_i32 s80, s80, 43008
    s_add_u32 s80, s80, s84
    s_mul_i32 s81, s79, 1024
    s_add_u32 s81, s81, 114688
    s_mov_b32 m0, s81
    s_add_u32 s79, s79, 4
    buffer_load_dwordx4 v4, s[12:15], s80 offen lds
    s_cmp_ge_u32 s79, 28
    s_cselect_b32 s80, 28, 0
    s_sub_u32 s79, s79, s80
    s_add_u32 s80, s79, 0
    s_mul_i32 s80, s80, 43008
    s_add_u32 s80, s80, s84
    s_mul_i32 s81, s79, 1024
    s_add_u32 s81, s81, 114688
    s_mov_b32 m0, s81
    s_add_u32 s79, s79, 4
    buffer_load_dwordx4 v4, s[12:15], s80 offen lds
    s_cmp_ge_u32 s79, 28
    s_cselect_b32 s80, 28, 0
    s_sub_u32 s79, s79, s80
    s_add_u32 s80, s79, 0
    s_mul_i32 s80, s80, 43008
    s_add_u32 s80, s80, s84
    s_mul_i32 s81, s79, 1024
    s_add_u32 s81, s81, 114688
    s_mov_b32 m0, s81
    s_add_u32 s79, s79, 4
    buffer_load_dwordx4 v4, s[12:15], s80 offen lds
    s_cmp_ge_u32 s79, 28
    s_cselect_b32 s80, 28, 0
    s_sub_u32 s79, s79, s80
    s_add_u32 s80, s79, 0
    s_mul_i32 s80, s80, 43008
    s_add_u32 s80, s80, s84
    s_mul_i32 s81, s79, 1024
    s_add_u32 s81, s81, 114688
    s_mov_b32 m0, s81
    s_add_u32 s79, s79, 4
    buffer_load_dwordx4 v4, s[12:15], s80 offen lds
    s_cmp_ge_u32 s79, 28
    s_cselect_b32 s80, 28, 0
    s_sub_u32 s79, s79, s80
    s_add_u32 s80, s79, 0
    s_mul_i32 s80, s80, 43008
    s_add_u32 s80, s80, s84
    s_mul_i32 s81, s79, 1024
    s_add_u32 s81, s81, 114688
    s_mov_b32 m0, s81
    s_add_u32 s79, s79, 4
    buffer_load_dwordx4 v4, s[12:15], s80 offen lds
    s_mul_i32 s79, s5, 19
    s_lshr_b32 s79, s79, 4
    s_add_u32 s79, s79, s6
    s_cmp_ge_u32 s79, 19
    s_cselect_b32 s80, 19, 0
    s_sub_u32 s79, s79, s80
    s_add_u32 s80, s79, 0
    s_mul_i32 s80, s80, 43008
    s_add_u32 s80, s80, s85
    s_mul_i32 s81, s79, 1024
    s_add_u32 s81, s81, 143360
    s_mov_b32 m0, s81
    s_add_u32 s79, s79, 4
    buffer_load_dwordx4 v4, s[12:15], s80 offen lds
    s_cmp_ge_u32 s79, 19
    s_cselect_b32 s80, 19, 0
    s_sub_u32 s79, s79, s80
    s_add_u32 s80, s79, 0
    s_mul_i32 s80, s80, 43008
    s_add_u32 s80, s80, s85
    s_mul_i32 s81, s79, 1024
    s_add_u32 s81, s81, 143360
    s_mov_b32 m0, s81
    s_add_u32 s79, s79, 4
    buffer_load_dwordx4 v4, s[12:15], s80 offen lds
    s_cmp_ge_u32 s79, 19
    s_cselect_b32 s80, 19, 0
    s_sub_u32 s79, s79, s80
    s_add_u32 s80, s79, 0
    s_mul_i32 s80, s80, 43008
    s_add_u32 s80, s80, s85
    s_mul_i32 s81, s79, 1024
    s_add_u32 s81, s81, 143360
    s_mov_b32 m0, s81
    s_add_u32 s79, s79, 4
    buffer_load_dwordx4 v4, s[12:15], s80 offen lds
    s_cmp_ge_u32 s79, 19
    s_cselect_b32 s80, 19, 0
    s_sub_u32 s79, s79, s80
    s_add_u32 s80, s79, 0
    s_mul_i32 s80, s80, 43008
    s_add_u32 s80, s80, s85
    s_mul_i32 s81, s79, 1024
    s_add_u32 s81, s81, 143360
    s_mov_b32 m0, s81
    s_add_u32 s79, s79, 4
    buffer_load_dwordx4 v4, s[12:15], s80 offen lds
    s_cmp_lt_u32 s6, 3
    s_cbranch_scc0 L_51
    s_cmp_ge_u32 s79, 19
    s_cselect_b32 s80, 19, 0
    s_sub_u32 s79, s79, s80
    s_add_u32 s80, s79, 0
    s_mul_i32 s80, s80, 43008
    s_add_u32 s80, s80, s85
    s_mul_i32 s81, s79, 1024
    s_add_u32 s81, s81, 143360
    s_mov_b32 m0, s81
    s_add_u32 s79, s79, 4
    buffer_load_dwordx4 v4, s[12:15], s80 offen lds
L_51:
    s_load_dwordx2 s[44:45], s[66:67], 196608
    s_mov_b32 s20, s56
    s_mov_b32 s21, s57
    s_mov_b32 s22, 1605632
    s_mov_b32 s23, 0x00020000
    s_mov_b32 s40, s66
    s_mov_b32 s41, s67
    s_mov_b32 s42, 268435456
    s_mov_b32 s43, 0x00020000
    s_mov_b32 s24, s58
    s_mov_b32 s25, s59
    s_mov_b32 s26, 3584
    s_mov_b32 s27, 0x00020000
    s_mov_b32 s32, s62
    s_mov_b32 s33, s63
    s_mov_b32 s34, 896
    s_mov_b32 s35, 0x00020000
    s_mov_b32 s36, s64
    s_mov_b32 s37, s65
    s_mov_b32 s38, 1835008
    s_mov_b32 s39, 0x00020000
    s_mov_b32 s8, s48
    s_mov_b32 s9, s49
    s_mov_b32 s10, 1835008
    s_mov_b32 s11, 0x00020000
    s_lshr_b32 s46, 0x15ab, s4
    s_and_b32 s46, s46, 1
    s_lshl_b32 s74, 1, s4
    s_sub_u32 s74, s74, 1
    s_and_b32 s74, s74, 0x15ab
    s_bcnt1_i32_b32 s74, s74
    s_cmp_eq_u32 s46, 1
    s_cbranch_scc0 L_52
    s_lshl_b32 s72, s74, 2
    s_add_u32 s73, s72, 2
    s_branch L_53
L_52:
    s_sub_u32 s74, s4, s74
    s_mul_i32 s72, s74, 3
    s_add_u32 s72, s72, 32
    s_and_b32 s74, s74, 1
    s_add_u32 s73, s72, 2
    s_cmp_eq_u32 s74, 0
    s_cselect_b32 s73, s73, s72
    s_add_u32 s72, s72, s74
L_53:
    s_cmp_eq_u32 s6, 3
    s_cbranch_scc1 L_54
    s_waitcnt vmcnt(5)
    s_branch L_55
L_54:
    s_waitcnt vmcnt(4)
L_55:
    s_mov_b64 exec, 1
    v_mov_b32 v2, 162836
    v_mov_b32 v3, 1
    ds_add_u32 v2, v3
    s_mov_b64 exec, -1
    v_and_b32 v10, 31, v1
    v_lshrrev_b32 v11, 5, v1
    v_mul_u32_u24 v11, 63, v11
    v_cmp_gt_u32 vcc, 28, v10
    s_nop 0
    s_and_saveexec_b64 s[90:91], vcc
    s_cmp_ge_u32 s6, 2
    s_cbranch_scc1 L_57
    v_mul_u32_u24 v10, 3584, v10
    s_cmp_eq_u32 s6, 0
    s_cselect_b32 s92, s72, s73
    s_lshl_b32 s92, s92, 6
    s_mul_i32 s93, s5, 100352
    s_add_u32 s92, s92, s93
    buffer_load_dword v52, v10, s[20:23], s92 offen
    s_branch L_59
L_57:
    v_mul_u32_u24 v10, 2688, v10
    v_add_u32 v10, v10, v11
    s_cmp_eq_u32 s6, 2
    s_cselect_b32 s92, s83, s85
    s_mul_i32 s93, s5, 75264
    s_add_u32 s92, s92, s93
    buffer_load_dword v52, v10, s[12:15], s92 offen
L_59:
    s_mov_b64 exec, s[90:91]
    s_add_u32 s80, s6, 0
    s_min_u32 s80, s80, 8
    s_add_u32 s80, s80, 19
    s_mul_i32 s80, s80, 43008
    s_add_u32 s80, s80, s85
    buffer_load_dwordx4 v[24:27], v4, s[12:15], s80 offen
    s_add_u32 s80, s6, 4
    s_min_u32 s80, s80, 8
    s_add_u32 s80, s80, 19
    s_mul_i32 s80, s80, 43008
    s_add_u32 s80, s80, s85
    buffer_load_dwordx4 v[28:31], v4, s[12:15], s80 offen
    s_add_u32 s80, s6, 8
    s_min_u32 s80, s80, 8
    s_add_u32 s80, s80, 19
    s_mul_i32 s80, s80, 43008
    s_add_u32 s80, s80, s85
    buffer_load_dwordx4 v[32:35], v4, s[12:15], s80 offen
    s_waitcnt vmcnt(4)
    s_mov_b64 exec, 1
    v_mov_b32 v2, 162888
    v_mov_b32 v3, 1
    ds_add_u32 v2, v3
    s_mov_b64 exec, -1
    v_lshlrev_b32 v2, 1, v1
    v_mov_b32 v3, 0x7ffffff0
    v_cmp_gt_u32 vcc, 32, v1
    s_nop 1
    v_cndmask_b32 v2, v3, v2, vcc
    s_lshl_b32 s76, s72, 6
    s_lshl_b32 s77, s73, 6
    buffer_load_ushort v16, v2, s[24:27], s76 offen
    buffer_load_ushort v17, v2, s[24:27], s76 offen offset:64
    buffer_load_ushort v18, v2, s[24:27], s77 offen
    buffer_load_ushort v19, v2, s[24:27], s77 offen offset:64
    s_waitcnt lgkmcnt(0)
    s_mul_i32 s44, s44, 0x9E3779B2
    s_add_u32 s44, s44, 0x7F4A7C15
    s_xor_b32 s45, s45, s44
    s_mul_i32 s45, s45, 0x85EBCA6A
    s_add_u32 s45, s45, 0x2545F491
    s_mul_i32 s79, s6, 28672
    v_lshrrev_b32 v3, 5, v1
    v_add_u32 v2, 0, v3
    v_xor_b32 v2, v2, v1
    v_lshlrev_b32 v2, 4, v2
    v_add_u32 v12, s79, v2
    v_add_u32 v2, 2, v3
    v_xor_b32 v2, v2, v1
    v_lshlrev_b32 v2, 4, v2
    v_add_u32 v13, s79, v2
    v_add_u32 v2, 4, v3
    v_xor_b32 v2, v2, v1
    v_lshlrev_b32 v2, 4, v2
    v_add_u32 v14, s79, v2
    v_add_u32 v2, 6, v3
    v_xor_b32 v2, v2, v1
    v_lshlrev_b32 v2, 4, v2
    v_add_u32 v15, s79, v2
    s_setprio 3
    v_mov_b32 v2, 162896
    s_mov_b32 s69, 0
L_sp_60:
    ds_read_b32 v3, v2
    s_add_u32 s69, s69, 1
    s_waitcnt lgkmcnt(0)
    v_readfirstlane_b32 s68, v3
    s_nop 0
    s_cmp_ge_u32 s68, 8
    s_cbranch_scc1 L_spd_61
    s_cmp_gt_u32 s69, 1048576
    s_cbranch_scc1 L_spd_61
    s_nop 0
    s_branch L_sp_60
L_spd_61:
    ds_read_b128 v[56:59], v12 offset:0
    ds_read_b128 v[60:63], v13 offset:1024
    ds_read_b128 v[64:67], v14 offset:2048
    ds_read_b128 v[68:71], v15 offset:3072
    ds_read_b128 v[72:75], v12 offset:4096
    ds_read_b128 v[76:79], v13 offset:5120
    ds_read_b128 v[80:83], v14 offset:6144
    ds_read_b128 v[84:87], v15 offset:7168
    ds_read_b128 v[88:91], v12 offset:8192
    ds_read_b128 v[92:95], v13 offset:9216
    ds_read_b128 v[96:99], v14 offset:10240
    ds_read_b128 v[100:103], v15 offset:11264
    ds_read_b128 v[104:107], v12 offset:12288
    ds_read_b128 v[108:111], v13 offset:13312
    ds_read_b128 v[112:115], v14 offset:14336
    ds_read_b128 v[116:119], v15 offset:15360
    ds_read_b128 v[120:123], v12 offset:16384
    ds_read_b128 v[124:127], v13 offset:17408
    ds_read_b128 v[128:131], v14 offset:18432
    ds_read_b128 v[132:135], v15 offset:19456
    ds_read_b128 v[136:139], v12 offset:20480
    ds_read_b128 v[140:143], v13 offset:21504
    ds_read_b128 v[144:147], v14 offset:22528
    ds_read_b128 v[148:151], v15 offset:23552
    ds_read_b128 v[152:155], v12 offset:24576
    ds_read_b128 v[156:159], v13 offset:25600
    ds_read_b128 v[160:163], v14 offset:26624
    ds_read_b128 v[164:167], v15 offset:27648
    s_waitcnt lgkmcnt(0)
    s_mov_b64 exec, 1
    v_mov_b32 v2, 162864
    v_mov_b32 v3, 1
    ds_add_u32 v2, v3
    s_mov_b64 exec, -1
    s_setprio 3
    v_mov_b32 v2, 162864
    s_mov_b32 s69, 0
L_sp_62:
    ds_read_b32 v3, v2
    s_add_u32 s69, s69, 1
    s_waitcnt lgkmcnt(0)
    v_readfirstlane_b32 s68, v3
    s_nop 0
    s_cmp_ge_u32 s68, 8
    s_cbranch_scc1 L_spd_63
    s_cmp_gt_u32 s69, 1048576
    s_cbranch_scc1 L_spd_63
    s_nop 0
    s_branch L_sp_62
L_spd_63:
    v_lshlrev_b32 v2, 4, v1
    s_lshl_b32 s80, s6, 10
    v_add_u32 v2, s80, v2
    s_waitcnt vmcnt(4)
    ds_write_b128 v2, v[24:27] offset:0
    ds_write_b128 v2, v[28:31] offset:4096
    s_cmp_lt_u32 s6, 1
    s_cbranch_scc0 L_64
    ds_write_b128 v2, v[32:35] offset:8192
L_64:
    s_waitcnt lgkmcnt(0)
    s_mov_b64 exec, 1
    v_mov_b32 v2, 162840
    v_mov_b32 v3, 1
    ds_add_u32 v2, v3
    s_mov_b64 exec, -1
    v_lshrrev_b32 v4, 4, v1
    v_and_b32 v2, 15, v1
    v_lshrrev_b32 v6, 2, v2
    v_and_b32 v2, 3, v2
    v_lshrrev_b32 v7, 1, v4
    v_and_b32 v4, 1, v4
    v_lshl_add_u32 v7, v7, 3, v6
    v_lshlrev_b32 v4, 5, v4
    v_lshl_add_u32 v4, v2, 3, v4
    v_lshl_add_u32 v8, v7, 6, v4
    v_lshrrev_b32 v6, 1, v6
    v_lshl_add_u32 v4, v6, 6, v4
    v_lshl_add_u32 v9, v7, 7, v4
    v_lshlrev_b32 v10, 4, v1
    v_mov_b32 v12, 0x3f80
    v_mov_b32 v13, 0
    v_cmp_gt_u32 vcc, 32, v1
    s_nop 1
    v_cndmask_b32 v12, v13, v12, vcc
    v_mov_b32 v14, 0
    v_mov_b32 v15, 0
    v_mov_b32 v21, 0
    v_mov_b32 v22, 0
    v_mov_b32 v23, 0
    s_add_u32 s74, s72, 1
    s_add_u32 s75, s73, 1
    v_mov_b32 v2, 162888
    s_mov_b32 s69, 0
L_sp_65:
    ds_read_b32 v3, v2
    s_add_u32 s69, s69, 1
    s_waitcnt lgkmcnt(0)
    v_readfirstlane_b32 s68, v3
    s_nop 0
    s_cmp_ge_u32 s68, 4
    s_cbranch_scc1 L_spd_66
    s_cmp_gt_u32 s69, 1048576
    s_cbranch_scc1 L_spd_66
    s_nop 0
    s_branch L_sp_65
L_spd_66:
    v_add_u32 v11, 143360, v8
    v_add_u32 v7, 0, v8
    s_setprio 3
    ds_read_b64_tr_b16 v[24:25], v11 offset:0
    ds_read_b64_tr_b16 v[26:27], v11 offset:256
    ds_read_b64_tr_b16 v[28:29], v11 offset:1024
    ds_read_b64_tr_b16 v[30:31], v11 offset:1280
    ds_read_b64_tr_b16 v[32:33], v11 offset:2048
    ds_read_b64_tr_b16 v[34:35], v11 offset:2304
    ds_read_b64_tr_b16 v[36:37], v11 offset:3072
    ds_read_b64_tr_b16 v[38:39], v11 offset:3328
    s_waitcnt lgkmcnt(6)
    v_mfma_f32_32x32x16_bf16 v[40:55], v[56:59], v[24:27], 0
    ds_read_b64_tr_b16 v[24:25], v11 offset:4096
    ds_read_b64_tr_b16 v[26:27], v11 offset:4352
    s_waitcnt lgkmcnt(6)
    v_mfma_f32_32x32x16_bf16 v[40:55], v[60:63], v[28:31], v[40:55]
    ds_read_b64_tr_b16 v[28:29], v11 offset:5120
    ds_read_b64_tr_b16 v[30:31], v11 offset:5376
    s_waitcnt lgkmcnt(6)
    v_mfma_f32_32x32x16_bf16 v[40:55], v[64:67], v[32:35], v[40:55]
    ds_read_b64_tr_b16 v[32:33], v11 offset:6144
    ds_read_b64_tr_b16 v[34:35], v11 offset:6400
    s_waitcnt lgkmcnt(6)
    v_mfma_f32_32x32x16_bf16 v[40:55], v[68:71], v[36:39], v[40:55]
    ds_read_b64_tr_b16 v[36:37], v11 offset:7168
    ds_read_b64_tr_b16 v[38:39], v11 offset:7424
    s_waitcnt lgkmcnt(6)
    v_mfma_f32_32x32x16_bf16 v[40:55], v[72:75], v[24:27], v[40:55]
    ds_read_b64_tr_b16 v[24:25], v11 offset:8192
    ds_read_b64_tr_b16 v[26:27], v11 offset:8448
    s_waitcnt lgkmcnt(6)
    v_mfma_f32_32x32x16_bf16 v[40:55], v[76:79], v[28:31], v[40:55]
    ds_read_b64_tr_b16 v[28:29], v11 offset:9216
    ds_read_b64_tr_b16 v[30:31], v11 offset:9472
    s_waitcnt lgkmcnt(6)
    v_mfma_f32_32x32x16_bf16 v[40:55], v[80:83], v[32:35], v[40:55]
    ds_read_b64_tr_b16 v[32:33], v11 offset:10240
    ds_read_b64_tr_b16 v[34:35], v11 offset:10496
    s_waitcnt lgkmcnt(6)
    v_mfma_f32_32x32x16_bf16 v[40:55], v[84:87], v[36:39], v[40:55]
    ds_read_b64_tr_b16 v[36:37], v11 offset:11264
    ds_read_b64_tr_b16 v[38:39], v11 offset:11520
    s_waitcnt lgkmcnt(6)
    v_mfma_f32_32x32x16_bf16 v[40:55], v[88:91], v[24:27], v[40:55]
    ds_read_b64_tr_b16 v[24:25], v11 offset:12288
    ds_read_b64_tr_b16 v[26:27], v11 offset:12544
    s_waitcnt lgkmcnt(6)
    v_mfma_f32_32x32x16_bf16 v[40:55], v[92:95], v[28:31], v[40:55]
    ds_read_b64_tr_b16 v[28:29], v11 offset:13312
    ds_read_b64_tr_b16 v[30:31], v11 offset:13568
    s_waitcnt lgkmcnt(6)
    v_mfma_f32_32x32x16_bf16 v[40:55], v[96:99], v[32:35], v[40:55]
    ds_read_b64_tr_b16 v[32:33], v11 offset:14336
    ds_read_b64_tr_b16 v[34:35], v11 offset:14592
    s_waitcnt lgkmcnt(6)
    v_mfma_f32_32x32x16_bf16 v[40:55], v[100:103], v[36:39], v[40:55]
    ds_read_b64_tr_b16 v[36:37], v11 offset:15360
    ds_read_b64_tr_b16 v[38:39], v11 offset:15616
    s_waitcnt lgkmcnt(6)
    v_mfma_f32_32x32x16_bf16 v[40:55], v[104:107], v[24:27], v[40:55]
    ds_read_b64_tr_b16 v[24:25], v11 offset:16384
    ds_read_b64_tr_b16 v[26:27], v11 offset:16640
    s_waitcnt lgkmcnt(6)
    v_mfma_f32_32x32x16_bf16 v[40:55], v[108:111], v[28:31], v[40:55]
    ds_read_b64_tr_b16 v[28:29], v11 offset:17408
    ds_read_b64_tr_b16 v[30:31], v11 offset:17664
    s_waitcnt lgkmcnt(6)
    v_mfma_f32_32x32x16_bf16 v[40:55], v[112:115], v[32:35], v[40:55]
    ds_read_b64_tr_b16 v[32:33], v11 offset:18432
    ds_read_b64_tr_b16 v[34:35], v11 offset:18688
    s_waitcnt lgkmcnt(6)
    v_mfma_f32_32x32x16_bf16 v[40:55], v[116:119], v[36:39], v[40:55]
    v_mov_b32 v2, 162840
    s_mov_b32 s69, 0
L_sp_67:
    ds_read_b32 v3, v2
    s_add_u32 s69, s69, 1
    s_waitcnt lgkmcnt(0)
    v_readfirstlane_b32 s68, v3
    s_nop 0
    s_cmp_ge_u32 s68, 4
    s_cbranch_scc1 L_spd_68
    s_cmp_gt_u32 s69, 1048576
    s_cbranch_scc1 L_spd_68
    s_sleep 1
    s_branch L_sp_67
L_spd_68:
    ds_read_b64_tr_b16 v[36:37], v7 offset:0
    ds_read_b64_tr_b16 v[38:39], v7 offset:256
    s_waitcnt lgkmcnt(6)
    v_mfma_f32_32x32x16_bf16 v[40:55], v[120:123], v[24:27], v[40:55]
    ds_read_b64_tr_b16 v[24:25], v7 offset:1024
    ds_read_b64_tr_b16 v[26:27], v7 offset:1280
    s_waitcnt lgkmcnt(6)
    v_mfma_f32_32x32x16_bf16 v[40:55], v[124:127], v[28:31], v[40:55]
    ds_read_b64_tr_b16 v[28:29], v7 offset:2048
    ds_read_b64_tr_b16 v[30:31], v7 offset:2304
    s_waitcnt lgkmcnt(6)
    v_mfma_f32_32x32x16_bf16 v[40:55], v[128:131], v[32:35], v[40:55]
    ds_read_b64_tr_b16 v[32:33], v7 offset:3072
    ds_read_b64_tr_b16 v[34:35], v7 offset:3328
    s_waitcnt lgkmcnt(6)
    v_mfma_f32_32x32x16_bf16 v[40:55], v[132:135], v[36:39], v[40:55]
    ds_read_b64_tr_b16 v[36:37], v7 offset:4096
    ds_read_b64_tr_b16 v[38:39], v7 offset:4352
    s_waitcnt lgkmcnt(6)
    v_mfma_f32_32x32x16_bf16 v[40:55], v[136:139], v[24:27], v[40:55]
    ds_read_b64_tr_b16 v[24:25], v7 offset:5120
    ds_read_b64_tr_b16 v[26:27], v7 offset:5376
    s_waitcnt lgkmcnt(6)
    v_mfma_f32_32x32x16_bf16 v[40:55], v[140:143], v[28:31], v[40:55]
    ds_read_b64_tr_b16 v[28:29], v7 offset:6144
    ds_read_b64_tr_b16 v[30:31], v7 offset:6400
    s_waitcnt lgkmcnt(6)
    v_mfma_f32_32x32x16_bf16 v[40:55], v[144:147], v[32:35], v[40:55]
    ds_read_b64_tr_b16 v[32:33], v7 offset:7168
    ds_read_b64_tr_b16 v[34:35], v7 offset:7424
    s_waitcnt lgkmcnt(6)
    v_mfma_f32_32x32x16_bf16 v[40:55], v[148:151], v[36:39], v[40:55]
    ds_read_b64_tr_b16 v[36:37], v7 offset:8192
    ds_read_b64_tr_b16 v[38:39], v7 offset:8448
    s_waitcnt lgkmcnt(6)
    v_mfma_f32_32x32x16_bf16 v[40:55], v[152:155], v[24:27], v[40:55]
    s_waitcnt lgkmcnt(4)
    v_mfma_f32_32x32x16_bf16 v[40:55], v[156:159], v[28:31], v[40:55]
    s_waitcnt lgkmcnt(2)
    v_mfma_f32_32x32x16_bf16 v[40:55], v[160:163], v[32:35], v[40:55]
    s_waitcnt lgkmcnt(0)
    v_mfma_f32_32x32x16_bf16 v[40:55], v[164:167], v[36:39], v[40:55]
    s_setprio 3
    s_mov_b64 exec, 1
    v_mov_b32 v2, 162860
    v_mov_b32 v3, 1
    ds_add_u32 v2, v3
    s_mov_b64 exec, -1
    v_and_b32 v4, 31, v1
    v_mov_b32 v5, 0
    v_mov_b32 v2, 0x3f803f80
    v_cmp_eq_u32 vcc, 28, v4
    s_nop 1
    v_cndmask_b32 v5, v5, v2, vcc
    v_cmp_le_u32 s[78:79], 28, v4
    v_cvt_pk_bf16_f32 v40, v40, v41
    v_cvt_pk_bf16_f32 v41, v42, v43
    v_cvt_pk_bf16_f32 v42, v44, v45
    v_cvt_pk_bf16_f32 v43, v46, v47
    v_cvt_pk_bf16_f32 v44, v48, v49
    v_cvt_pk_bf16_f32 v45, v50, v51
    v_cvt_pk_bf16_f32 v46, v52, v53
    v_cvt_pk_bf16_f32 v47, v54, v55
    v_cndmask_b32 v40, v40, v5, s[78:79]
    v_cndmask_b32 v41, v41, v5, s[78:79]
    v_cndmask_b32 v42, v42, v5, s[78:79]
    v_cndmask_b32 v43, v43, v5, s[78:79]
    v_cndmask_b32 v44, v44, v5, s[78:79]
    v_cndmask_b32 v45, v45, v5, s[78:79]
    v_cndmask_b32 v46, v46, v5, s[78:79]
    v_cndmask_b32 v47, v47, v5, s[78:79]
    s_lshl_b32 s68, s4, 18
    s_lshl_b32 s69, s5, 14
    s_add_u32 s68, s68, s69
    s_lshl_b32 s69, s6, 12
    s_add_u32 s68, s68, s69
    s_add_u32 s68, s68, 1050624
    buffer_store_dwordx4 v[40:43], v10, s[40:43], s68 offen sc1
    buffer_store_dwordx4 v[44:47], v10, s[40:43], s68 offen offset:1024 sc1
    s_waitcnt vmcnt(2)
    v_mov_b32 v2, 162844
    s_mov_b32 s69, 0
L_sp_69:
    ds_read_b32 v3, v2
    s_add_u32 s69, s69, 1
    s_waitcnt lgkmcnt(0)
    v_readfirstlane_b32 s68, v3
    s_nop 0
    s_cmp_ge_u32 s68, 4
    s_cbranch_scc1 L_spd_70
    s_cmp_gt_u32 s69, 1048576
    s_cbranch_scc1 L_spd_70
    s_nop 0
    s_branch L_sp_69
L_spd_70:
    v_add_u32 v11, 28672, v9
    s_setprio 3
    ds_read_b64_tr_b16 v[24:25], v11 offset:0
    ds_read_b64_tr_b16 v[26:27], v11 offset:512
    ds_read_b64_tr_b16 v[28:29], v11 offset:2048
    ds_read_b64_tr_b16 v[30:31], v11 offset:2560
    ds_read_b64_tr_b16 v[32:33], v11 offset:4096
    ds_read_b64_tr_b16 v[34:35], v11 offset:4608
    v_mov_b32 v20, v16
    s_nop 1
    v_mfma_f32_32x32x16_bf16 v[40:55], v[20:23], v[12:15], 0
    ds_read_b64_tr_b16 v[36:37], v11 offset:6144
    ds_read_b64_tr_b16 v[38:39], v11 offset:6656
    s_waitcnt lgkmcnt(6)
    v_mfma_f32_32x32x16_bf16 v[40:55], v[24:27], v[56:59], v[40:55]
    ds_read_b64_tr_b16 v[24:25], v11 offset:8192
    ds_read_b64_tr_b16 v[26:27], v11 offset:8704
    s_waitcnt lgkmcnt(6)
    v_mfma_f32_32x32x16_bf16 v[40:55], v[28:31], v[60:63], v[40:55]
    ds_read_b64_tr_b16 v[28:29], v11 offset:10240
    ds_read_b64_tr_b16 v[30:31], v11 offset:10752
    s_waitcnt lgkmcnt(6)
    v_mfma_f32_32x32x16_bf16 v[40:55], v[32:35], v[64:67], v[40:55]
    ds_read_b64_tr_b16 v[32:33], v11 offset:12288
    ds_read_b64_tr_b16 v[34:35], v11 offset:12800
    s_waitcnt lgkmcnt(6)
    v_mfma_f32_32x32x16_bf16 v[40:55], v[36:39], v[68:71], v[40:55]
    ds_read_b64_tr_b16 v[36:37], v11 offset:14336
    ds_read_b64_tr_b16 v[38:39], v11 offset:14848
    s_waitcnt lgkmcnt(6)
    v_mfma_f32_32x32x16_bf16 v[40:55], v[24:27], v[72:75], v[40:55]
    ds_read_b64_tr_b16 v[24:25], v11 offset:16384
    ds_read_b64_tr_b16 v[26:27], v11 offset:16896
    s_waitcnt lgkmcnt(6)
    v_mfma_f32_32x32x16_bf16 v[40:55], v[28:31], v[76:79], v[40:55]
    ds_read_b64_tr_b16 v[28:29], v11 offset:18432
    ds_read_b64_tr_b16 v[30:31], v11 offset:18944
    s_waitcnt lgkmcnt(6)
    v_mfma_f32_32x32x16_bf16 v[40:55], v[32:35], v[80:83], v[40:55]
    ds_read_b64_tr_b16 v[32:33], v11 offset:20480
    ds_read_b64_tr_b16 v[34:35], v11 offset:20992
    s_waitcnt lgkmcnt(6)
    v_mfma_f32_32x32x16_bf16 v[40:55], v[36:39], v[84:87], v[40:55]
    ds_read_b64_tr_b16 v[36:37], v11 offset:22528
    ds_read_b64_tr_b16 v[38:39], v11 offset:23040
    s_waitcnt lgkmcnt(6)
    v_mfma_f32_32x32x16_bf16 v[40:55], v[24:27], v[88:91], v[40:55]
    ds_read_b64_tr_b16 v[24:25], v11 offset:24576
    ds_read_b64_tr_b16 v[26:27], v11 offset:25088
    s_waitcnt lgkmcnt(6)
    v_mfma_f32_32x32x16_bf16 v[40:55], v[28:31], v[92:95], v[40:55]
    ds_read_b64_tr_b16 v[28:29], v11 offset:26624
    ds_read_b64_tr_b16 v[30:31], v11 offset:27136
    s_waitcnt lgkmcnt(6)
    v_mfma_f32_32x32x16_bf16 v[40:55], v[32:35], v[96:99], v[40:55]
    ds_read_b64_tr_b16 v[32:33], v11 offset:28672
    ds_read_b64_tr_b16 v[34:35], v11 offset:29184
    s_waitcnt lgkmcnt(6)
    v_mfma_f32_32x32x16_bf16 v[40:55], v[36:39], v[100:103], v[40:55]
    s_waitcnt vmcnt(0)
    s_mov_b64 exec, 1
    v_mov_b32 v2, 162816
    v_mov_b32 v3, 1
    ds_add_rtn_u32 v2, v2, v3
    s_waitcnt lgkmcnt(0)
    v_readfirstlane_b32 s68, v2
    s_nop 0
    s_cmp_eq_u32 s68, 7
    s_cbranch_scc0 L_pub_71
    s_lshl_b32 s68, s4, 4
    s_add_u32 s68, s68, s5
    s_lshl_b32 s68, s68, 7
    s_add_u32 s68, s68, 0
    v_mov_b32 v4, s68
    v_mov_b32 v2, s44
    v_mov_b32 v3, s45
    buffer_store_dwordx2 v[2:3], v4, s[40:43], 0 offen sc1
L_pub_71:
    s_mov_b64 exec, -1
    ds_read_b64_tr_b16 v[36:37], v11 offset:30720
    ds_read_b64_tr_b16 v[38:39], v11 offset:31232
    s_waitcnt lgkmcnt(6)
    v_mfma_f32_32x32x16_bf16 v[40:55], v[24:27], v[104:107], v[40:55]
    ds_read_b64_tr_b16 v[24:25], v11 offset:32768
    ds_read_b64_tr_b16 v[26:27], v11 offset:33280
    s_waitcnt lgkmcnt(6)
    v_mfma_f32_32x32x16_bf16 v[40:55], v[28:31], v[108:111], v[40:55]
    ds_read_b64_tr_b16 v[28:29], v11 offset:34816
    ds_read_b64_tr_b16 v[30:31], v11 offset:35328
    s_waitcnt lgkmcnt(6)
    v_mfma_f32_32x32x16_bf16 v[40:55], v[32:35], v[112:115], v[40:55]
    ds_read_b64_tr_b16 v[32:33], v11 offset:36864
    ds_read_b64_tr_b16 v[34:35], v11 offset:37376
    s_waitcnt lgkmcnt(6)
    v_mfma_f32_32x32x16_bf16 v[40:55], v[36:39], v[116:119], v[40:55]
    ds_read_b64_tr_b16 v[36:37], v11 offset:38912
    ds_read_b64_tr_b16 v[38:39], v11 offset:39424
    s_waitcnt lgkmcnt(6)
    v_mfma_f32_32x32x16_bf16 v[40:55], v[24:27], v[120:123], v[40:55]
    ds_read_b64_tr_b16 v[24:25], v11 offset:40960
    ds_read_b64_tr_b16 v[26:27], v11 offset:41472
    s_waitcnt lgkmcnt(6)
    v_mfma_f32_32x32x16_bf16 v[40:55], v[28:31], v[124:127], v[40:55]
    ds_read_b64_tr_b16 v[28:29], v11 offset:43008
    ds_read_b64_tr_b16 v[30:31], v11 offset:43520
    s_waitcnt lgkmcnt(6)
    v_mfma_f32_32x32x16_bf16 v[40:55], v[32:35], v[128:131], v[40:55]
    ds_read_b64_tr_b16 v[32:33], v11 offset:45056
    ds_read_b64_tr_b16 v[34:35], v11 offset:45568
    s_waitcnt lgkmcnt(6)
    v_mfma_f32_32x32x16_bf16 v[40:55], v[36:39], v[132:135], v[40:55]
    ds_read_b64_tr_b16 v[36:37], v11 offset:47104
    ds_read_b64_tr_b16 v[38:39], v11 offset:47616
    s_waitcnt lgkmcnt(6)
    v_mfma_f32_32x32x16_bf16 v[40:55], v[24:27], v[136:139], v[40:55]
    ds_read_b64_tr_b16 v[24:25], v11 offset:49152
    ds_read_b64_tr_b16 v[26:27], v11 offset:49664
    s_waitcnt lgkmcnt(6)
    v_mfma_f32_32x32x16_bf16 v[40:55], v[28:31], v[140:143], v[40:55]
    ds_read_b64_tr_b16 v[28:29], v11 offset:51200
    ds_read_b64_tr_b16 v[30:31], v11 offset:51712
    s_waitcnt lgkmcnt(6)
    v_mfma_f32_32x32x16_bf16 v[40:55], v[32:35], v[144:147], v[40:55]
    ds_read_b64_tr_b16 v[32:33], v11 offset:53248
    ds_read_b64_tr_b16 v[34:35], v11 offset:53760
    s_waitcnt lgkmcnt(6)
    v_mfma_f32_32x32x16_bf16 v[40:55], v[36:39], v[148:151], v[40:55]
    ds_read_b64_tr_b16 v[36:37], v11 offset:55296
    ds_read_b64_tr_b16 v[38:39], v11 offset:55808
    s_waitcnt lgkmcnt(6)
    v_mfma_f32_32x32x16_bf16 v[40:55], v[24:27], v[152:155], v[40:55]
    s_waitcnt lgkmcnt(4)
    v_mfma_f32_32x32x16_bf16 v[40:55], v[28:31], v[156:159], v[40:55]
    s_waitcnt lgkmcnt(2)
    v_mfma_f32_32x32x16_bf16 v[40:55], v[32:35], v[160:163], v[40:55]
    s_waitcnt lgkmcnt(0)
    v_mfma_f32_32x32x16_bf16 v[40:55], v[36:39], v[164:167], v[40:55]
    s_setprio 3
    s_nop 10
    v_max_f32 v40, 0, v40
    v_max_f32 v41, 0, v41
    v_max_f32 v42, 0, v42
    v_max_f32 v43, 0, v43
    v_max_f32 v44, 0, v44
    v_max_f32 v45, 0, v45
    v_max_f32 v46, 0, v46
    v_max_f32 v47, 0, v47
    v_max_f32 v48, 0, v48
    v_max_f32 v49, 0, v49
    v_max_f32 v50, 0, v50
    v_max_f32 v51, 0, v51
    v_max_f32 v52, 0, v52
    v_max_f32 v53, 0, v53
    v_max_f32 v54, 0, v54
    v_max_f32 v55, 0, v55
    v_mul_f32 v40, v40, v40
    v_mul_f32 v41, v41, v41
    v_mul_f32 v42, v42, v42
    v_mul_f32 v43, v43, v43
    v_mul_f32 v44, v44, v44
    v_mul_f32 v45, v45, v45
    v_mul_f32 v46, v46, v46
    v_mul_f32 v47, v47, v47
    v_mul_f32 v48, v48, v48
    v_mul_f32 v49, v49, v49
    v_mul_f32 v50, v50, v50
    v_mul_f32 v51, v51, v51
    v_mul_f32 v52, v52, v52
    v_mul_f32 v53, v53, v53
    v_mul_f32 v54, v54, v54
    v_mul_f32 v55, v55, v55
    v_cvt_pk_bf16_f32 v40, v40, v41
    v_cvt_pk_bf16_f32 v41, v42, v43
    v_cvt_pk_bf16_f32 v42, v44, v45
    v_cvt_pk_bf16_f32 v43, v46, v47
    v_cvt_pk_bf16_f32 v44, v48, v49
    v_cvt_pk_bf16_f32 v45, v50, v51
    v_cvt_pk_bf16_f32 v46, v52, v53
    v_cvt_pk_bf16_f32 v47, v54, v55
    s_lshl_b32 s68, s5, 2
    s_add_u32 s68, s68, s6
    s_mul_i32 s68, s68, 112
    s_lshl_b32 s69, s72, 1
    s_add_u32 s68, s68, s69
    s_lshl_b32 s68, s68, 10
    s_add_u32 s68, s68, 5242880
    buffer_store_dwordx4 v[40:43], v10, s[40:43], s68 offen sc1
    buffer_store_dwordx4 v[44:47], v10, s[40:43], s68 offen offset:1024 sc1
    v_xor_b32 v9, 64, v9
    v_add_u32 v11, 28672, v9
    s_setprio 3
    ds_read_b64_tr_b16 v[24:25], v11 offset:0
    ds_read_b64_tr_b16 v[26:27], v11 offset:512
    ds_read_b64_tr_b16 v[28:29], v11 offset:2048
    ds_read_b64_tr_b16 v[30:31], v11 offset:2560
    ds_read_b64_tr_b16 v[32:33], v11 offset:4096
    ds_read_b64_tr_b16 v[34:35], v11 offset:4608
    v_mov_b32 v20, v17
    s_nop 1
    v_mfma_f32_32x32x16_bf16 v[40:55], v[20:23], v[12:15], 0
    ds_read_b64_tr_b16 v[36:37], v11 offset:6144
    ds_read_b64_tr_b16 v[38:39], v11 offset:6656
    s_waitcnt lgkmcnt(6)
    v_mfma_f32_32x32x16_bf16 v[40:55], v[24:27], v[56:59], v[40:55]
    ds_read_b64_tr_b16 v[24:25], v11 offset:8192
    ds_read_b64_tr_b16 v[26:27], v11 offset:8704
    s_waitcnt lgkmcnt(6)
    v_mfma_f32_32x32x16_bf16 v[40:55], v[28:31], v[60:63], v[40:55]
    ds_read_b64_tr_b16 v[28:29], v11 offset:10240
    ds_read_b64_tr_b16 v[30:31], v11 offset:10752
    s_waitcnt lgkmcnt(6)
    v_mfma_f32_32x32x16_bf16 v[40:55], v[32:35], v[64:67], v[40:55]
    ds_read_b64_tr_b16 v[32:33], v11 offset:12288
    ds_read_b64_tr_b16 v[34:35], v11 offset:12800
    s_waitcnt lgkmcnt(6)
    v_mfma_f32_32x32x16_bf16 v[40:55], v[36:39], v[68:71], v[40:55]
    ds_read_b64_tr_b16 v[36:37], v11 offset:14336
    ds_read_b64_tr_b16 v[38:39], v11 offset:14848
    s_waitcnt lgkmcnt(6)
    v_mfma_f32_32x32x16_bf16 v[40:55], v[24:27], v[72:75], v[40:55]
    ds_read_b64_tr_b16 v[24:25], v11 offset:16384
    ds_read_b64_tr_b16 v[26:27], v11 offset:16896
    s_waitcnt lgkmcnt(6)
    v_mfma_f32_32x32x16_bf16 v[40:55], v[28:31], v[76:79], v[40:55]
    ds_read_b64_tr_b16 v[28:29], v11 offset:18432
    ds_read_b64_tr_b16 v[30:31], v11 offset:18944
    s_waitcnt lgkmcnt(6)
    v_mfma_f32_32x32x16_bf16 v[40:55], v[32:35], v[80:83], v[40:55]
    ds_read_b64_tr_b16 v[32:33], v11 offset:20480
    ds_read_b64_tr_b16 v[34:35], v11 offset:20992
    s_waitcnt lgkmcnt(6)
    v_mfma_f32_32x32x16_bf16 v[40:55], v[36:39], v[84:87], v[40:55]
    ds_read_b64_tr_b16 v[36:37], v11 offset:22528
    ds_read_b64_tr_b16 v[38:39], v11 offset:23040
    s_waitcnt lgkmcnt(6)
    v_mfma_f32_32x32x16_bf16 v[40:55], v[24:27], v[88:91], v[40:55]
    ds_read_b64_tr_b16 v[24:25], v11 offset:24576
    ds_read_b64_tr_b16 v[26:27], v11 offset:25088
    s_waitcnt lgkmcnt(6)
    v_mfma_f32_32x32x16_bf16 v[40:55], v[28:31], v[92:95], v[40:55]
    ds_read_b64_tr_b16 v[28:29], v11 offset:26624
    ds_read_b64_tr_b16 v[30:31], v11 offset:27136
    s_waitcnt lgkmcnt(6)
    v_mfma_f32_32x32x16_bf16 v[40:55], v[32:35], v[96:99], v[40:55]
    ds_read_b64_tr_b16 v[32:33], v11 offset:28672
    ds_read_b64_tr_b16 v[34:35], v11 offset:29184
    s_waitcnt lgkmcnt(6)
    v_mfma_f32_32x32x16_bf16 v[40:55], v[36:39], v[100:103], v[40:55]
    ds_read_b64_tr_b16 v[36:37], v11 offset:30720
    ds_read_b64_tr_b16 v[38:39], v11 offset:31232
    s_waitcnt lgkmcnt(6)
    v_mfma_f32_32x32x16_bf16 v[40:55], v[24:27], v[104:107], v[40:55]
    ds_read_b64_tr_b16 v[24:25], v11 offset:32768
    ds_read_b64_tr_b16 v[26:27], v11 offset:33280
    s_waitcnt lgkmcnt(6)
    v_mfma_f32_32x32x16_bf16 v[40:55], v[28:31], v[108:111], v[40:55]
    ds_read_b64_tr_b16 v[28:29], v11 offset:34816
    ds_read_b64_tr_b16 v[30:31], v11 offset:35328
    s_waitcnt lgkmcnt(6)
    v_mfma_f32_32x32x16_bf16 v[40:55], v[32:35], v[112:115], v[40:55]
    ds_read_b64_tr_b16 v[32:33], v11 offset:36864
    ds_read_b64_tr_b16 v[34:35], v11 offset:37376
    s_waitcnt lgkmcnt(6)
    v_mfma_f32_32x32x16_bf16 v[40:55], v[36:39], v[116:119], v[40:55]
    ds_read_b64_tr_b16 v[36:37], v11 offset:38912
    ds_read_b64_tr_b16 v[38:39], v11 offset:39424
    s_waitcnt lgkmcnt(6)
    v_mfma_f32_32x32x16_bf16 v[40:55], v[24:27], v[120:123], v[40:55]
    ds_read_b64_tr_b16 v[24:25], v11 offset:40960
    ds_read_b64_tr_b16 v[26:27], v11 offset:41472
    s_waitcnt lgkmcnt(6)
    v_mfma_f32_32x32x16_bf16 v[40:55], v[28:31], v[124:127], v[40:55]
    ds_read_b64_tr_b16 v[28:29], v11 offset:43008
    ds_read_b64_tr_b16 v[30:31], v11 offset:43520
    s_waitcnt lgkmcnt(6)
    v_mfma_f32_32x32x16_bf16 v[40:55], v[32:35], v[128:131], v[40:55]
    ds_read_b64_tr_b16 v[32:33], v11 offset:45056
    ds_read_b64_tr_b16 v[34:35], v11 offset:45568
    s_waitcnt lgkmcnt(6)
    v_mfma_f32_32x32x16_bf16 v[40:55], v[36:39], v[132:135], v[40:55]
    ds_read_b64_tr_b16 v[36:37], v11 offset:47104
    ds_read_b64_tr_b16 v[38:39], v11 offset:47616
    s_waitcnt lgkmcnt(6)
    v_mfma_f32_32x32x16_bf16 v[40:55], v[24:27], v[136:139], v[40:55]
    ds_read_b64_tr_b16 v[24:25], v11 offset:49152
    ds_read_b64_tr_b16 v[26:27], v11 offset:49664
    s_waitcnt lgkmcnt(6)
    v_mfma_f32_32x32x16_bf16 v[40:55], v[28:31], v[140:143], v[40:55]
    ds_read_b64_tr_b16 v[28:29], v11 offset:51200
    ds_read_b64_tr_b16 v[30:31], v11 offset:51712
    s_waitcnt lgkmcnt(6)
    v_mfma_f32_32x32x16_bf16 v[40:55], v[32:35], v[144:147], v[40:55]
    ds_read_b64_tr_b16 v[32:33], v11 offset:53248
    ds_read_b64_tr_b16 v[34:35], v11 offset:53760
    s_waitcnt lgkmcnt(6)
    v_mfma_f32_32x32x16_bf16 v[40:55], v[36:39], v[148:151], v[40:55]
    ds_read_b64_tr_b16 v[36:37], v11 offset:55296
    ds_read_b64_tr_b16 v[38:39], v11 offset:55808
    s_waitcnt lgkmcnt(6)
    v_mfma_f32_32x32x16_bf16 v[40:55], v[24:27], v[152:155], v[40:55]
    s_waitcnt lgkmcnt(4)
    v_mfma_f32_32x32x16_bf16 v[40:55], v[28:31], v[156:159], v[40:55]
    s_waitcnt lgkmcnt(2)
    v_mfma_f32_32x32x16_bf16 v[40:55], v[32:35], v[160:163], v[40:55]
    s_waitcnt lgkmcnt(0)
    v_mfma_f32_32x32x16_bf16 v[40:55], v[36:39], v[164:167], v[40:55]
    s_setprio 3
    v_lshrrev_b32 v6, 3, v1
    v_mul_u32_u24 v6, 896, v6
    v_and_b32 v7, 7, v1
    v_lshl_add_u32 v6, v7, 4, v6
    s_lshl_b32 s88, s2, 2
    s_add_u32 s88, s88, s6
    s_min_u32 s90, s88, 1007
    s_mul_i32 s89, s90, 7282
    s_lshr_b32 s89, s89, 20
    s_mul_i32 s91, s89, 144
    s_sub_u32 s90, s90, s91
    s_lshl_b32 s92, s89, 7
    s_cmp_lt_u32 s90, 112
    s_cbranch_scc0 L_72
    s_mul_i32 s93, s90, 14336
    s_add_u32 s93, s93, s92
    s_add_u32 s94, s93, 7168
    buffer_load_dwordx4 v[24:27], v6, s[28:31], s93 offen
    buffer_load_dwordx4 v[28:31], v6, s[28:31], s94 offen
    s_branch L_73
L_72:
    s_sub_u32 s93, s90, 112
    s_lshr_b32 s94, s93, 1
    s_mul_i32 s94, s94, 28
    s_and_b32 s93, s93, 1
    s_lshl_b32 s93, s93, 4
    s_add_u32 s93, s93, s94
    s_mul_i32 s93, s93, 896
    s_add_u32 s93, s93, s92
    s_add_u32 s94, s93, 7168
    buffer_load_dwordx4 v[24:27], v6, s[16:19], s93 offen
    buffer_load_dwordx4 v[28:31], v6, s[16:19], s94 offen
L_73:
    v_max_f32 v40, 0, v40
    v_max_f32 v41, 0, v41
    v_max_f32 v42, 0, v42
    v_max_f32 v43, 0, v43
    v_max_f32 v44, 0, v44
    v_max_f32 v45, 0, v45
    v_max_f32 v46, 0, v46
    v_max_f32 v47, 0, v47
    v_max_f32 v48, 0, v48
    v_max_f32 v49, 0, v49
    v_max_f32 v50, 0, v50
    v_max_f32 v51, 0, v51
    v_max_f32 v52, 0, v52
    v_max_f32 v53, 0, v53
    v_max_f32 v54, 0, v54
    v_max_f32 v55, 0, v55
    v_mul_f32 v40, v40, v40
    v_mul_f32 v41, v41, v41
    v_mul_f32 v42, v42, v42
    v_mul_f32 v43, v43, v43
    v_mul_f32 v44, v44, v44
    v_mul_f32 v45, v45, v45
    v_mul_f32 v46, v46, v46
    v_mul_f32 v47, v47, v47
    v_mul_f32 v48, v48, v48
    v_mul_f32 v49, v49, v49
    v_mul_f32 v50, v50, v50
    v_mul_f32 v51, v51, v51
    v_mul_f32 v52, v52, v52
    v_mul_f32 v53, v53, v53
    v_mul_f32 v54, v54, v54
    v_mul_f32 v55, v55, v55
    v_cvt_pk_bf16_f32 v40, v40, v41
    v_cvt_pk_bf16_f32 v41, v42, v43
    v_cvt_pk_bf16_f32 v42, v44, v45
    v_cvt_pk_bf16_f32 v43, v46, v47
    v_cvt_pk_bf16_f32 v44, v48, v49
    v_cvt_pk_bf16_f32 v45, v50, v51
    v_cvt_pk_bf16_f32 v46, v52, v53
    v_cvt_pk_bf16_f32 v47, v54, v55
    s_lshl_b32 s68, s5, 2
    s_add_u32 s68, s68, s6
    s_mul_i32 s68, s68, 112
    s_lshl_b32 s69, s74, 1
    s_add_u32 s68, s68, s69
    s_lshl_b32 s68, s68, 10
    s_add_u32 s68, s68, 5242880
    buffer_store_dwordx4 v[40:43], v10, s[40:43], s68 offen sc1
    buffer_store_dwordx4 v[44:47], v10, s[40:43], s68 offen offset:1024 sc1
    v_xor_b32 v9, 64, v9
    v_mov_b32 v2, 162860
    s_mov_b32 s69, 0
L_sp_74:
    ds_read_b32 v3, v2
    s_add_u32 s69, s69, 1
    s_waitcnt lgkmcnt(0)
    v_readfirstlane_b32 s68, v3
    s_nop 0
    s_cmp_ge_u32 s68, 4
    s_cbranch_scc1 L_spd_75
    s_cmp_gt_u32 s69, 1048576
    s_cbranch_scc1 L_spd_75
    s_sleep 1
    s_branch L_sp_74
L_spd_75:
    s_waitcnt vmcnt(2)
    s_lshl_b32 s88, s2, 2
    s_add_u32 s88, s88, s6
    s_lshl_b32 s91, s6, 11
    s_add_u32 s91, s91, 151552
    v_lshrrev_b32 v2, 4, v1
    v_and_b32 v3, 15, v1
    v_lshrrev_b32 v4, 2, v3
    v_and_b32 v3, 3, v3
    v_lshrrev_b32 v5, 1, v2
    v_and_b32 v2, 1, v2
    v_lshl_add_u32 v5, v5, 2, v4
    v_lshlrev_b32 v5, 7, v5
    v_lshrrev_b32 v4, 1, v4
    v_lshl_add_u32 v5, v4, 6, v5
    v_lshl_add_u32 v5, v2, 5, v5
    v_lshl_add_u32 v5, v3, 3, v5
    v_add_u32 v5, s91, v5
    v_xor_b32 v6, 64, v5
    v_bfe_u32 v7, v1, 4, 1
    v_lshlrev_b32 v7, 2, v7
    v_and_b32 v2, 7, v1
    v_xor_b32 v7, v7, v2
    v_lshlrev_b32 v7, 4, v7
    v_lshrrev_b32 v2, 3, v1
    v_lshl_add_u32 v7, v2, 7, v7
    v_add_u32 v7, s91, v7
    ds_write_b128 v7, v[24:27]
    ds_write_b128 v7, v[28:31] offset:1024
    s_waitcnt lgkmcnt(0)
    ds_read_b64_tr_b16 v[32:33], v5
    ds_read_b64_tr_b16 v[34:35], v5 offset:1024
    ds_read_b64_tr_b16 v[36:37], v6
    ds_read_b64_tr_b16 v[38:39], v6 offset:1024
    s_lshl_b32 s93, s88, 11
    s_add_u32 s93, s93, 14680064
    s_waitcnt lgkmcnt(0)
    buffer_store_dwordx4 v[32:35], v10, s[40:43], s93 offen sc1
    buffer_store_dwordx4 v[36:39], v10, s[40:43], s93 offen offset:1024 sc1
    v_mov_b32 v2, 162848
    s_mov_b32 s69, 0
L_sp_76:
    ds_read_b32 v3, v2
    s_add_u32 s69, s69, 1
    s_waitcnt lgkmcnt(0)
    v_readfirstlane_b32 s68, v3
    s_nop 0
    s_cmp_ge_u32 s68, 3
    s_cbranch_scc1 L_spd_77
    s_cmp_gt_u32 s69, 1048576
    s_cbranch_scc1 L_spd_77
    s_sleep 1
    s_branch L_sp_76
L_spd_77:
    s_cmp_eq_u32 s46, 1
    s_cbranch_scc0 L_78
    v_add_u32 v11, 86016, v9
    s_setprio 3
    ds_read_b64_tr_b16 v[24:25], v11 offset:0
    ds_read_b64_tr_b16 v[26:27], v11 offset:512
    ds_read_b64_tr_b16 v[28:29], v11 offset:2048
    ds_read_b64_tr_b16 v[30:31], v11 offset:2560
    ds_read_b64_tr_b16 v[32:33], v11 offset:4096
    ds_read_b64_tr_b16 v[34:35], v11 offset:4608
    v_mov_b32 v20, v18
    s_nop 1
    v_mfma_f32_32x32x16_bf16 v[40:55], v[20:23], v[12:15], 0
    ds_read_b64_tr_b16 v[36:37], v11 offset:6144
    ds_read_b64_tr_b16 v[38:39], v11 offset:6656
    s_waitcnt lgkmcnt(6)
    v_mfma_f32_32x32x16_bf16 v[40:55], v[24:27], v[56:59], v[40:55]
    ds_read_b64_tr_b16 v[24:25], v11 offset:8192
    ds_read_b64_tr_b16 v[26:27], v11 offset:8704
    s_waitcnt lgkmcnt(6)
    v_mfma_f32_32x32x16_bf16 v[40:55], v[28:31], v[60:63], v[40:55]
    ds_read_b64_tr_b16 v[28:29], v11 offset:10240
    ds_read_b64_tr_b16 v[30:31], v11 offset:10752
    s_waitcnt lgkmcnt(6)
    v_mfma_f32_32x32x16_bf16 v[40:55], v[32:35], v[64:67], v[40:55]
    ds_read_b64_tr_b16 v[32:33], v11 offset:12288
    ds_read_b64_tr_b16 v[34:35], v11 offset:12800
    s_waitcnt lgkmcnt(6)
    v_mfma_f32_32x32x16_bf16 v[40:55], v[36:39], v[68:71], v[40:55]
    ds_read_b64_tr_b16 v[36:37], v11 offset:14336
    ds_read_b64_tr_b16 v[38:39], v11 offset:14848
    s_waitcnt lgkmcnt(6)
    v_mfma_f32_32x32x16_bf16 v[40:55], v[24:27], v[72:75], v[40:55]
    ds_read_b64_tr_b16 v[24:25], v11 offset:16384
    ds_read_b64_tr_b16 v[26:27], v11 offset:16896
    s_waitcnt lgkmcnt(6)
    v_mfma_f32_32x32x16_bf16 v[40:55], v[28:31], v[76:79], v[40:55]
    ds_read_b64_tr_b16 v[28:29], v11 offset:18432
    ds_read_b64_tr_b16 v[30:31], v11 offset:18944
    s_waitcnt lgkmcnt(6)
    v_mfma_f32_32x32x16_bf16 v[40:55], v[32:35], v[80:83], v[40:55]
    ds_read_b64_tr_b16 v[32:33], v11 offset:20480
    ds_read_b64_tr_b16 v[34:35], v11 offset:20992
    s_waitcnt lgkmcnt(6)
    v_mfma_f32_32x32x16_bf16 v[40:55], v[36:39], v[84:87], v[40:55]
    ds_read_b64_tr_b16 v[36:37], v11 offset:22528
    ds_read_b64_tr_b16 v[38:39], v11 offset:23040
    s_waitcnt lgkmcnt(6)
    v_mfma_f32_32x32x16_bf16 v[40:55], v[24:27], v[88:91], v[40:55]
    ds_read_b64_tr_b16 v[24:25], v11 offset:24576
    ds_read_b64_tr_b16 v[26:27], v11 offset:25088
    s_waitcnt lgkmcnt(6)
    v_mfma_f32_32x32x16_bf16 v[40:55], v[28:31], v[92:95], v[40:55]
    ds_read_b64_tr_b16 v[28:29], v11 offset:26624
    ds_read_b64_tr_b16 v[30:31], v11 offset:27136
    s_waitcnt lgkmcnt(6)
    v_mfma_f32_32x32x16_bf16 v[40:55], v[32:35], v[96:99], v[40:55]
    ds_read_b64_tr_b16 v[32:33], v11 offset:28672
    ds_read_b64_tr_b16 v[34:35], v11 offset:29184
    s_waitcnt lgkmcnt(6)
    v_mfma_f32_32x32x16_bf16 v[40:55], v[36:39], v[100:103], v[40:55]
    ds_read_b64_tr_b16 v[36:37], v11 offset:30720
    ds_read_b64_tr_b16 v[38:39], v11 offset:31232
    s_waitcnt lgkmcnt(6)
    v_mfma_f32_32x32x16_bf16 v[40:55], v[24:27], v[104:107], v[40:55]
    ds_read_b64_tr_b16 v[24:25], v11 offset:32768
    ds_read_b64_tr_b16 v[26:27], v11 offset:33280
    s_waitcnt lgkmcnt(6)
    v_mfma_f32_32x32x16_bf16 v[40:55], v[28:31], v[108:111], v[40:55]
    ds_read_b64_tr_b16 v[28:29], v11 offset:34816
    ds_read_b64_tr_b16 v[30:31], v11 offset:35328
    s_waitcnt lgkmcnt(6)
    v_mfma_f32_32x32x16_bf16 v[40:55], v[32:35], v[112:115], v[40:55]
    ds_read_b64_tr_b16 v[32:33], v11 offset:36864
    ds_read_b64_tr_b16 v[34:35], v11 offset:37376
    s_waitcnt lgkmcnt(6)
    v_mfma_f32_32x32x16_bf16 v[40:55], v[36:39], v[116:119], v[40:55]
    ds_read_b64_tr_b16 v[36:37], v11 offset:38912
    ds_read_b64_tr_b16 v[38:39], v11 offset:39424
    s_waitcnt lgkmcnt(6)
    v_mfma_f32_32x32x16_bf16 v[40:55], v[24:27], v[120:123], v[40:55]
    ds_read_b64_tr_b16 v[24:25], v11 offset:40960
    ds_read_b64_tr_b16 v[26:27], v11 offset:41472
    s_waitcnt lgkmcnt(6)
    v_mfma_f32_32x32x16_bf16 v[40:55], v[28:31], v[124:127], v[40:55]
    ds_read_b64_tr_b16 v[28:29], v11 offset:43008
    ds_read_b64_tr_b16 v[30:31], v11 offset:43520
    s_waitcnt lgkmcnt(6)
    v_mfma_f32_32x32x16_bf16 v[40:55], v[32:35], v[128:131], v[40:55]
    ds_read_b64_tr_b16 v[32:33], v11 offset:45056
    ds_read_b64_tr_b16 v[34:35], v11 offset:45568
    s_waitcnt lgkmcnt(6)
    v_mfma_f32_32x32x16_bf16 v[40:55], v[36:39], v[132:135], v[40:55]
    ds_read_b64_tr_b16 v[36:37], v11 offset:47104
    ds_read_b64_tr_b16 v[38:39], v11 offset:47616
    s_waitcnt lgkmcnt(6)
    v_mfma_f32_32x32x16_bf16 v[40:55], v[24:27], v[136:139], v[40:55]
    ds_read_b64_tr_b16 v[24:25], v11 offset:49152
    ds_read_b64_tr_b16 v[26:27], v11 offset:49664
    s_waitcnt lgkmcnt(6)
    v_mfma_f32_32x32x16_bf16 v[40:55], v[28:31], v[140:143], v[40:55]
    s_waitcnt vmcnt(0)
    s_mov_b64 exec, 1
    v_mov_b32 v2, 162876
    v_mov_b32 v3, 1
    ds_add_rtn_u32 v2, v2, v3
    s_waitcnt lgkmcnt(0)
    v_readfirstlane_b32 s68, v2
    s_nop 0
    s_cmp_eq_u32 s68, 3
    s_cbranch_scc0 L_pub_80
    s_lshl_b32 s68, s4, 4
    s_add_u32 s68, s68, s5
    s_lshl_b32 s68, s68, 7
    s_add_u32 s68, s68, 98304
    v_mov_b32 v4, s68
    v_mov_b32 v2, s44
    v_mov_b32 v3, s45
    buffer_store_dwordx2 v[2:3], v4, s[40:43], 0 offen sc1
L_pub_80:
    s_mov_b64 exec, -1
    ds_read_b64_tr_b16 v[28:29], v11 offset:51200
    ds_read_b64_tr_b16 v[30:31], v11 offset:51712
    s_waitcnt lgkmcnt(6)
    v_mfma_f32_32x32x16_bf16 v[40:55], v[32:35], v[144:147], v[40:55]
    ds_read_b64_tr_b16 v[32:33], v11 offset:53248
    ds_read_b64_tr_b16 v[34:35], v11 offset:53760
    s_waitcnt lgkmcnt(6)
    v_mfma_f32_32x32x16_bf16 v[40:55], v[36:39], v[148:151], v[40:55]
    ds_read_b64_tr_b16 v[36:37], v11 offset:55296
    ds_read_b64_tr_b16 v[38:39], v11 offset:55808
    s_waitcnt lgkmcnt(6)
    v_mfma_f32_32x32x16_bf16 v[40:55], v[24:27], v[152:155], v[40:55]
    s_waitcnt lgkmcnt(4)
    v_mfma_f32_32x32x16_bf16 v[40:55], v[28:31], v[156:159], v[40:55]
    s_waitcnt lgkmcnt(2)
    v_mfma_f32_32x32x16_bf16 v[40:55], v[32:35], v[160:163], v[40:55]
    s_waitcnt lgkmcnt(0)
    v_mfma_f32_32x32x16_bf16 v[40:55], v[36:39], v[164:167], v[40:55]
    s_setprio 3
    s_nop 10
    v_max_f32 v40, 0, v40
    v_max_f32 v41, 0, v41
    v_max_f32 v42, 0, v42
    v_max_f32 v43, 0, v43
    v_max_f32 v44, 0, v44
    v_max_f32 v45, 0, v45
    v_max_f32 v46, 0, v46
    v_max_f32 v47, 0, v47
    v_max_f32 v48, 0, v48
    v_max_f32 v49, 0, v49
    v_max_f32 v50, 0, v50
    v_max_f32 v51, 0, v51
    v_max_f32 v52, 0, v52
    v_max_f32 v53, 0, v53
    v_max_f32 v54, 0, v54
    v_max_f32 v55, 0, v55
    v_mul_f32 v40, v40, v40
    v_mul_f32 v41, v41, v41
    v_mul_f32 v42, v42, v42
    v_mul_f32 v43, v43, v43
    v_mul_f32 v44, v44, v44
    v_mul_f32 v45, v45, v45
    v_mul_f32 v46, v46, v46
    v_mul_f32 v47, v47, v47
    v_mul_f32 v48, v48, v48
    v_mul_f32 v49, v49, v49
    v_mul_f32 v50, v50, v50
    v_mul_f32 v51, v51, v51
    v_mul_f32 v52, v52, v52
    v_mul_f32 v53, v53, v53
    v_mul_f32 v54, v54, v54
    v_mul_f32 v55, v55, v55
    v_cvt_pk_bf16_f32 v40, v40, v41
    v_cvt_pk_bf16_f32 v41, v42, v43
    v_cvt_pk_bf16_f32 v42, v44, v45
    v_cvt_pk_bf16_f32 v43, v46, v47
    v_cvt_pk_bf16_f32 v44, v48, v49
    v_cvt_pk_bf16_f32 v45, v50, v51
    v_cvt_pk_bf16_f32 v46, v52, v53
    v_cvt_pk_bf16_f32 v47, v54, v55
    s_lshl_b32 s68, s5, 2
    s_add_u32 s68, s68, s6
    s_mul_i32 s68, s68, 112
    s_lshl_b32 s69, s73, 1
    s_add_u32 s68, s68, s69
    s_lshl_b32 s68, s68, 10
    s_add_u32 s68, s68, 5242880
    buffer_store_dwordx4 v[40:43], v10, s[40:43], s68 offen sc1
    buffer_store_dwordx4 v[44:47], v10, s[40:43], s68 offen offset:1024 sc1
    v_xor_b32 v9, 64, v9
    v_add_u32 v11, 86016, v9
    s_setprio 3
    ds_read_b64_tr_b16 v[24:25], v11 offset:0
    ds_read_b64_tr_b16 v[26:27], v11 offset:512
    ds_read_b64_tr_b16 v[28:29], v11 offset:2048
    ds_read_b64_tr_b16 v[30:31], v11 offset:2560
    ds_read_b64_tr_b16 v[32:33], v11 offset:4096
    ds_read_b64_tr_b16 v[34:35], v11 offset:4608
    v_mov_b32 v20, v19
    s_nop 1
    v_mfma_f32_32x32x16_bf16 v[40:55], v[20:23], v[12:15], 0
    ds_read_b64_tr_b16 v[36:37], v11 offset:6144
    ds_read_b64_tr_b16 v[38:39], v11 offset:6656
    s_waitcnt lgkmcnt(6)
    v_mfma_f32_32x32x16_bf16 v[40:55], v[24:27], v[56:59], v[40:55]
    ds_read_b64_tr_b16 v[24:25], v11 offset:8192
    ds_read_b64_tr_b16 v[26:27], v11 offset:8704
    s_waitcnt lgkmcnt(6)
    v_mfma_f32_32x32x16_bf16 v[40:55], v[28:31], v[60:63], v[40:55]
    ds_read_b64_tr_b16 v[28:29], v11 offset:10240
    ds_read_b64_tr_b16 v[30:31], v11 offset:10752
    s_waitcnt lgkmcnt(6)
    v_mfma_f32_32x32x16_bf16 v[40:55], v[32:35], v[64:67], v[40:55]
    ds_read_b64_tr_b16 v[32:33], v11 offset:12288
    ds_read_b64_tr_b16 v[34:35], v11 offset:12800
    s_waitcnt lgkmcnt(6)
    v_mfma_f32_32x32x16_bf16 v[40:55], v[36:39], v[68:71], v[40:55]
    ds_read_b64_tr_b16 v[36:37], v11 offset:14336
    ds_read_b64_tr_b16 v[38:39], v11 offset:14848
    s_waitcnt lgkmcnt(6)
    v_mfma_f32_32x32x16_bf16 v[40:55], v[24:27], v[72:75], v[40:55]
    ds_read_b64_tr_b16 v[24:25], v11 offset:16384
    ds_read_b64_tr_b16 v[26:27], v11 offset:16896
    s_waitcnt lgkmcnt(6)
    v_mfma_f32_32x32x16_bf16 v[40:55], v[28:31], v[76:79], v[40:55]
    ds_read_b64_tr_b16 v[28:29], v11 offset:18432
    ds_read_b64_tr_b16 v[30:31], v11 offset:18944
    s_waitcnt lgkmcnt(6)
    v_mfma_f32_32x32x16_bf16 v[40:55], v[32:35], v[80:83], v[40:55]
    ds_read_b64_tr_b16 v[32:33], v11 offset:20480
    ds_read_b64_tr_b16 v[34:35], v11 offset:20992
    s_waitcnt lgkmcnt(6)
    v_mfma_f32_32x32x16_bf16 v[40:55], v[36:39], v[84:87], v[40:55]
    ds_read_b64_tr_b16 v[36:37], v11 offset:22528
    ds_read_b64_tr_b16 v[38:39], v11 offset:23040
    s_waitcnt lgkmcnt(6)
    v_mfma_f32_32x32x16_bf16 v[40:55], v[24:27], v[88:91], v[40:55]
    ds_read_b64_tr_b16 v[24:25], v11 offset:24576
    ds_read_b64_tr_b16 v[26:27], v11 offset:25088
    s_waitcnt lgkmcnt(6)
    v_mfma_f32_32x32x16_bf16 v[40:55], v[28:31], v[92:95], v[40:55]
    ds_read_b64_tr_b16 v[28:29], v11 offset:26624
    ds_read_b64_tr_b16 v[30:31], v11 offset:27136
    s_waitcnt lgkmcnt(6)
    v_mfma_f32_32x32x16_bf16 v[40:55], v[32:35], v[96:99], v[40:55]
    ds_read_b64_tr_b16 v[32:33], v11 offset:28672
    ds_read_b64_tr_b16 v[34:35], v11 offset:29184
    s_waitcnt lgkmcnt(6)
    v_mfma_f32_32x32x16_bf16 v[40:55], v[36:39], v[100:103], v[40:55]
    ds_read_b64_tr_b16 v[36:37], v11 offset:30720
    ds_read_b64_tr_b16 v[38:39], v11 offset:31232
    s_waitcnt lgkmcnt(6)
    v_mfma_f32_32x32x16_bf16 v[40:55], v[24:27], v[104:107], v[40:55]
    ds_read_b64_tr_b16 v[24:25], v11 offset:32768
    ds_read_b64_tr_b16 v[26:27], v11 offset:33280
    s_waitcnt lgkmcnt(6)
    v_mfma_f32_32x32x16_bf16 v[40:55], v[28:31], v[108:111], v[40:55]
    ds_read_b64_tr_b16 v[28:29], v11 offset:34816
    ds_read_b64_tr_b16 v[30:31], v11 offset:35328
    s_waitcnt lgkmcnt(6)
    v_mfma_f32_32x32x16_bf16 v[40:55], v[32:35], v[112:115], v[40:55]
    ds_read_b64_tr_b16 v[32:33], v11 offset:36864
    ds_read_b64_tr_b16 v[34:35], v11 offset:37376
    s_waitcnt lgkmcnt(6)
    v_mfma_f32_32x32x16_bf16 v[40:55], v[36:39], v[116:119], v[40:55]
    ds_read_b64_tr_b16 v[36:37], v11 offset:38912
    ds_read_b64_tr_b16 v[38:39], v11 offset:39424
    s_waitcnt lgkmcnt(6)
    v_mfma_f32_32x32x16_bf16 v[40:55], v[24:27], v[120:123], v[40:55]
    ds_read_b64_tr_b16 v[24:25], v11 offset:40960
    ds_read_b64_tr_b16 v[26:27], v11 offset:41472
    s_waitcnt lgkmcnt(6)
    v_mfma_f32_32x32x16_bf16 v[40:55], v[28:31], v[124:127], v[40:55]
    ds_read_b64_tr_b16 v[28:29], v11 offset:43008
    ds_read_b64_tr_b16 v[30:31], v11 offset:43520
    s_waitcnt lgkmcnt(6)
    v_mfma_f32_32x32x16_bf16 v[40:55], v[32:35], v[128:131], v[40:55]
    ds_read_b64_tr_b16 v[32:33], v11 offset:45056
    ds_read_b64_tr_b16 v[34:35], v11 offset:45568
    s_waitcnt lgkmcnt(6)
    v_mfma_f32_32x32x16_bf16 v[40:55], v[36:39], v[132:135], v[40:55]
    ds_read_b64_tr_b16 v[36:37], v11 offset:47104
    ds_read_b64_tr_b16 v[38:39], v11 offset:47616
    s_waitcnt lgkmcnt(6)
    v_mfma_f32_32x32x16_bf16 v[40:55], v[24:27], v[136:139], v[40:55]
    ds_read_b64_tr_b16 v[24:25], v11 offset:49152
    ds_read_b64_tr_b16 v[26:27], v11 offset:49664
    s_waitcnt lgkmcnt(6)
    v_mfma_f32_32x32x16_bf16 v[40:55], v[28:31], v[140:143], v[40:55]
    ds_read_b64_tr_b16 v[28:29], v11 offset:51200
    ds_read_b64_tr_b16 v[30:31], v11 offset:51712
    s_waitcnt lgkmcnt(6)
    v_mfma_f32_32x32x16_bf16 v[40:55], v[32:35], v[144:147], v[40:55]
    ds_read_b64_tr_b16 v[32:33], v11 offset:53248
    ds_read_b64_tr_b16 v[34:35], v11 offset:53760
    s_waitcnt lgkmcnt(6)
    v_mfma_f32_32x32x16_bf16 v[40:55], v[36:39], v[148:151], v[40:55]
    ds_read_b64_tr_b16 v[36:37], v11 offset:55296
    ds_read_b64_tr_b16 v[38:39], v11 offset:55808
    s_waitcnt lgkmcnt(6)
    v_mfma_f32_32x32x16_bf16 v[40:55], v[24:27], v[152:155], v[40:55]
    s_waitcnt lgkmcnt(4)
    v_mfma_f32_32x32x16_bf16 v[40:55], v[28:31], v[156:159], v[40:55]
    s_waitcnt lgkmcnt(2)
    v_mfma_f32_32x32x16_bf16 v[40:55], v[32:35], v[160:163], v[40:55]
    s_waitcnt lgkmcnt(0)
    v_mfma_f32_32x32x16_bf16 v[40:55], v[36:39], v[164:167], v[40:55]
    s_setprio 3
    s_mov_b64 exec, 1
    v_mov_b32 v2, 162920
    v_mov_b32 v3, 1
    ds_add_u32 v2, v3
    s_mov_b64 exec, -1
    s_nop 5
    v_max_f32 v40, 0, v40
    v_max_f32 v41, 0, v41
    v_max_f32 v42, 0, v42
    v_max_f32 v43, 0, v43
    v_max_f32 v44, 0, v44
    v_max_f32 v45, 0, v45
    v_max_f32 v46, 0, v46
    v_max_f32 v47, 0, v47
    v_max_f32 v48, 0, v48
    v_max_f32 v49, 0, v49
    v_max_f32 v50, 0, v50
    v_max_f32 v51, 0, v51
    v_max_f32 v52, 0, v52
    v_max_f32 v53, 0, v53
    v_max_f32 v54, 0, v54
    v_max_f32 v55, 0, v55
    v_mul_f32 v40, v40, v40
    v_mul_f32 v41, v41, v41
    v_mul_f32 v42, v42, v42
    v_mul_f32 v43, v43, v43
    v_mul_f32 v44, v44, v44
    v_mul_f32 v45, v45, v45
    v_mul_f32 v46, v46, v46
    v_mul_f32 v47, v47, v47
    v_mul_f32 v48, v48, v48
    v_mul_f32 v49, v49, v49
    v_mul_f32 v50, v50, v50
    v_mul_f32 v51, v51, v51
    v_mul_f32 v52, v52, v52
    v_mul_f32 v53, v53, v53
    v_mul_f32 v54, v54, v54
    v_mul_f32 v55, v55, v55
    v_cvt_pk_bf16_f32 v40, v40, v41
    v_cvt_pk_bf16_f32 v41, v42, v43
    v_cvt_pk_bf16_f32 v42, v44, v45
    v_cvt_pk_bf16_f32 v43, v46, v47
    v_cvt_pk_bf16_f32 v44, v48, v49
    v_cvt_pk_bf16_f32 v45, v50, v51
    v_cvt_pk_bf16_f32 v46, v52, v53
    v_cvt_pk_bf16_f32 v47, v54, v55
    s_lshl_b32 s68, s5, 2
    s_add_u32 s68, s68, s6
    s_mul_i32 s68, s68, 112
    s_lshl_b32 s69, s75, 1
    s_add_u32 s68, s68, s69
    s_lshl_b32 s68, s68, 10
    s_add_u32 s68, s68, 5242880
    buffer_store_dwordx4 v[40:43], v10, s[40:43], s68 offen sc1
    buffer_store_dwordx4 v[44:47], v10, s[40:43], s68 offen offset:1024 sc1
    s_branch L_79
L_78:
    v_add_u32 v11, 114688, v8
    s_setprio 3
    ds_read_b64_tr_b16 v[24:25], v11 offset:0
    ds_read_b64_tr_b16 v[26:27], v11 offset:256
    ds_read_b64_tr_b16 v[28:29], v11 offset:1024
    ds_read_b64_tr_b16 v[30:31], v11 offset:1280
    ds_read_b64_tr_b16 v[32:33], v11 offset:2048
    ds_read_b64_tr_b16 v[34:35], v11 offset:2304
    v_mov_b32 v20, v18
    s_nop 1
    v_mfma_f32_32x32x16_bf16 v[40:55], v[20:23], v[12:15], 0
    ds_read_b64_tr_b16 v[36:37], v11 offset:3072
    ds_read_b64_tr_b16 v[38:39], v11 offset:3328
    s_waitcnt lgkmcnt(6)
    v_mfma_f32_32x32x16_bf16 v[40:55], v[24:27], v[56:59], v[40:55]
    ds_read_b64_tr_b16 v[24:25], v11 offset:4096
    ds_read_b64_tr_b16 v[26:27], v11 offset:4352
    s_waitcnt lgkmcnt(6)
    v_mfma_f32_32x32x16_bf16 v[40:55], v[28:31], v[60:63], v[40:55]
    ds_read_b64_tr_b16 v[28:29], v11 offset:5120
    ds_read_b64_tr_b16 v[30:31], v11 offset:5376
    s_waitcnt lgkmcnt(6)
    v_mfma_f32_32x32x16_bf16 v[40:55], v[32:35], v[64:67], v[40:55]
    ds_read_b64_tr_b16 v[32:33], v11 offset:6144
    ds_read_b64_tr_b16 v[34:35], v11 offset:6400
    s_waitcnt lgkmcnt(6)
    v_mfma_f32_32x32x16_bf16 v[40:55], v[36:39], v[68:71], v[40:55]
    ds_read_b64_tr_b16 v[36:37], v11 offset:7168
    ds_read_b64_tr_b16 v[38:39], v11 offset:7424
    s_waitcnt lgkmcnt(6)
    v_mfma_f32_32x32x16_bf16 v[40:55], v[24:27], v[72:75], v[40:55]
    ds_read_b64_tr_b16 v[24:25], v11 offset:8192
    ds_read_b64_tr_b16 v[26:27], v11 offset:8448
    s_waitcnt lgkmcnt(6)
    v_mfma_f32_32x32x16_bf16 v[40:55], v[28:31], v[76:79], v[40:55]
    ds_read_b64_tr_b16 v[28:29], v11 offset:9216
    ds_read_b64_tr_b16 v[30:31], v11 offset:9472
    s_waitcnt lgkmcnt(6)
    v_mfma_f32_32x32x16_bf16 v[40:55], v[32:35], v[80:83], v[40:55]
    ds_read_b64_tr_b16 v[32:33], v11 offset:10240
    ds_read_b64_tr_b16 v[34:35], v11 offset:10496
    s_waitcnt lgkmcnt(6)
    v_mfma_f32_32x32x16_bf16 v[40:55], v[36:39], v[84:87], v[40:55]
    ds_read_b64_tr_b16 v[36:37], v11 offset:11264
    ds_read_b64_tr_b16 v[38:39], v11 offset:11520
    s_waitcnt lgkmcnt(6)
    v_mfma_f32_32x32x16_bf16 v[40:55], v[24:27], v[88:91], v[40:55]
    ds_read_b64_tr_b16 v[24:25], v11 offset:12288
    ds_read_b64_tr_b16 v[26:27], v11 offset:12544
    s_waitcnt lgkmcnt(6)
    v_mfma_f32_32x32x16_bf16 v[40:55], v[28:31], v[92:95], v[40:55]
    ds_read_b64_tr_b16 v[28:29], v11 offset:13312
    ds_read_b64_tr_b16 v[30:31], v11 offset:13568
    s_waitcnt lgkmcnt(6)
    v_mfma_f32_32x32x16_bf16 v[40:55], v[32:35], v[96:99], v[40:55]
    ds_read_b64_tr_b16 v[32:33], v11 offset:14336
    ds_read_b64_tr_b16 v[34:35], v11 offset:14592
    s_waitcnt lgkmcnt(6)
    v_mfma_f32_32x32x16_bf16 v[40:55], v[36:39], v[100:103], v[40:55]
    ds_read_b64_tr_b16 v[36:37], v11 offset:15360
    ds_read_b64_tr_b16 v[38:39], v11 offset:15616
    s_waitcnt lgkmcnt(6)
    v_mfma_f32_32x32x16_bf16 v[40:55], v[24:27], v[104:107], v[40:55]
    ds_read_b64_tr_b16 v[24:25], v11 offset:16384
    ds_read_b64_tr_b16 v[26:27], v11 offset:16640
    s_waitcnt lgkmcnt(6)
    v_mfma_f32_32x32x16_bf16 v[40:55], v[28:31], v[108:111], v[40:55]
    ds_read_b64_tr_b16 v[28:29], v11 offset:17408
    ds_read_b64_tr_b16 v[30:31], v11 offset:17664
    s_waitcnt lgkmcnt(6)
    v_mfma_f32_32x32x16_bf16 v[40:55], v[32:35], v[112:115], v[40:55]
    ds_read_b64_tr_b16 v[32:33], v11 offset:18432
    ds_read_b64_tr_b16 v[34:35], v11 offset:18688
    s_waitcnt lgkmcnt(6)
    v_mfma_f32_32x32x16_bf16 v[40:55], v[36:39], v[116:119], v[40:55]
    ds_read_b64_tr_b16 v[36:37], v11 offset:19456
    ds_read_b64_tr_b16 v[38:39], v11 offset:19712
    s_waitcnt lgkmcnt(6)
    v_mfma_f32_32x32x16_bf16 v[40:55], v[24:27], v[120:123], v[40:55]
    ds_read_b64_tr_b16 v[24:25], v11 offset:20480
    ds_read_b64_tr_b16 v[26:27], v11 offset:20736
    s_waitcnt lgkmcnt(6)
    v_mfma_f32_32x32x16_bf16 v[40:55], v[28:31], v[124:127], v[40:55]
    ds_read_b64_tr_b16 v[28:29], v11 offset:21504
    ds_read_b64_tr_b16 v[30:31], v11 offset:21760
    s_waitcnt lgkmcnt(6)
    v_mfma_f32_32x32x16_bf16 v[40:55], v[32:35], v[128:131], v[40:55]
    ds_read_b64_tr_b16 v[32:33], v11 offset:22528
    ds_read_b64_tr_b16 v[34:35], v11 offset:22784
    s_waitcnt lgkmcnt(6)
    v_mfma_f32_32x32x16_bf16 v[40:55], v[36:39], v[132:135], v[40:55]
    ds_read_b64_tr_b16 v[36:37], v11 offset:23552
    ds_read_b64_tr_b16 v[38:39], v11 offset:23808
    s_waitcnt lgkmcnt(6)
    v_mfma_f32_32x32x16_bf16 v[40:55], v[24:27], v[136:139], v[40:55]
    ds_read_b64_tr_b16 v[24:25], v11 offset:24576
    ds_read_b64_tr_b16 v[26:27], v11 offset:24832
    s_waitcnt lgkmcnt(6)
    v_mfma_f32_32x32x16_bf16 v[40:55], v[28:31], v[140:143], v[40:55]
    s_waitcnt vmcnt(0)
    s_mov_b64 exec, 1
    v_mov_b32 v2, 162876
    v_mov_b32 v3, 1
    ds_add_rtn_u32 v2, v2, v3
    s_waitcnt lgkmcnt(0)
    v_readfirstlane_b32 s68, v2
    s_nop 0
    s_cmp_eq_u32 s68, 3
    s_cbranch_scc0 L_pub_81
    s_lshl_b32 s68, s4, 4
    s_add_u32 s68, s68, s5
    s_lshl_b32 s68, s68, 7
    s_add_u32 s68, s68, 98304
    v_mov_b32 v4, s68
    v_mov_b32 v2, s44
    v_mov_b32 v3, s45
    buffer_store_dwordx2 v[2:3], v4, s[40:43], 0 offen sc1
L_pub_81:
    s_mov_b64 exec, -1
    ds_read_b64_tr_b16 v[28:29], v11 offset:25600
    ds_read_b64_tr_b16 v[30:31], v11 offset:25856
    s_waitcnt lgkmcnt(6)
    v_mfma_f32_32x32x16_bf16 v[40:55], v[32:35], v[144:147], v[40:55]
    ds_read_b64_tr_b16 v[32:33], v11 offset:26624
    ds_read_b64_tr_b16 v[34:35], v11 offset:26880
    s_waitcnt lgkmcnt(6)
    v_mfma_f32_32x32x16_bf16 v[40:55], v[36:39], v[148:151], v[40:55]
    ds_read_b64_tr_b16 v[36:37], v11 offset:27648
    ds_read_b64_tr_b16 v[38:39], v11 offset:27904
    s_waitcnt lgkmcnt(6)
    v_mfma_f32_32x32x16_bf16 v[40:55], v[24:27], v[152:155], v[40:55]
    s_waitcnt lgkmcnt(4)
    v_mfma_f32_32x32x16_bf16 v[40:55], v[28:31], v[156:159], v[40:55]
    s_waitcnt lgkmcnt(2)
    v_mfma_f32_32x32x16_bf16 v[40:55], v[32:35], v[160:163], v[40:55]
    s_waitcnt lgkmcnt(0)
    v_mfma_f32_32x32x16_bf16 v[40:55], v[36:39], v[164:167], v[40:55]
    s_setprio 3
    s_mov_b64 exec, 1
    v_mov_b32 v2, 162920
    v_mov_b32 v3, 1
    ds_add_u32 v2, v3
    s_mov_b64 exec, -1
    s_nop 5
    v_max_f32 v40, 0, v40
    v_max_f32 v41, 0, v41
    v_max_f32 v42, 0, v42
    v_max_f32 v43, 0, v43
    v_max_f32 v44, 0, v44
    v_max_f32 v45, 0, v45
    v_max_f32 v46, 0, v46
    v_max_f32 v47, 0, v47
    v_max_f32 v48, 0, v48
    v_max_f32 v49, 0, v49
    v_max_f32 v50, 0, v50
    v_max_f32 v51, 0, v51
    v_max_f32 v52, 0, v52
    v_max_f32 v53, 0, v53
    v_max_f32 v54, 0, v54
    v_max_f32 v55, 0, v55
    v_mul_f32 v40, v40, v40
    v_mul_f32 v41, v41, v41
    v_mul_f32 v42, v42, v42
    v_mul_f32 v43, v43, v43
    v_mul_f32 v44, v44, v44
    v_mul_f32 v45, v45, v45
    v_mul_f32 v46, v46, v46
    v_mul_f32 v47, v47, v47
    v_mul_f32 v48, v48, v48
    v_mul_f32 v49, v49, v49
    v_mul_f32 v50, v50, v50
    v_mul_f32 v51, v51, v51
    v_mul_f32 v52, v52, v52
    v_mul_f32 v53, v53, v53
    v_mul_f32 v54, v54, v54
    v_mul_f32 v55, v55, v55
    v_cvt_pk_bf16_f32 v40, v40, v41
    v_cvt_pk_bf16_f32 v41, v42, v43
    v_cvt_pk_bf16_f32 v42, v44, v45
    v_cvt_pk_bf16_f32 v43, v46, v47
    v_cvt_pk_bf16_f32 v44, v48, v49
    v_cvt_pk_bf16_f32 v45, v50, v51
    v_cvt_pk_bf16_f32 v46, v52, v53
    v_cvt_pk_bf16_f32 v47, v54, v55
    s_lshl_b32 s68, s5, 2
    s_add_u32 s68, s68, s6
    s_mul_i32 s68, s68, 112
    s_lshl_b32 s69, s73, 1
    s_add_u32 s68, s68, s69
    s_lshl_b32 s68, s68, 10
    s_add_u32 s68, s68, 5242880
    buffer_store_dwordx4 v[40:43], v10, s[40:43], s68 offen sc1
    buffer_store_dwordx4 v[44:47], v10, s[40:43], s68 offen offset:1024 sc1
L_79:
    s_waitcnt vmcnt(0)
    s_mov_b64 exec, 1
    v_mov_b32 v2, 162820
    v_mov_b32 v3, 1
    ds_add_rtn_u32 v2, v2, v3
    s_waitcnt lgkmcnt(0)
    v_readfirstlane_b32 s68, v2
    s_nop 0
    s_cmp_eq_u32 s68, 3
    s_cbranch_scc0 L_pub_82
    s_lshl_b32 s68, s4, 4
    s_add_u32 s68, s68, s5
    s_lshl_b32 s68, s68, 7
    s_add_u32 s68, s68, 32768
    v_mov_b32 v4, s68
    v_mov_b32 v2, s44
    v_mov_b32 v3, s45
    buffer_store_dwordx2 v[2:3], v4, s[40:43], 0 offen sc1
L_pub_82:
    s_mov_b64 exec, -1
    s_lshr_b32 s68, s2, 3
    s_cmp_ge_u32 s68, 28
    s_cbranch_scc1 L_auxexit_83
    s_mul_i32 s69, s68, 37
    s_lshr_b32 s69, s69, 8
    s_mul_i32 s70, s69, 7
    s_sub_u32 s71, s68, s70
    s_and_b32 s70, s2, 7
    s_lshl_b32 s70, s70, 2
    s_add_u32 s70, s70, s69
    s_setprio 3
    v_lshlrev_b32 v2, 4, v1
    s_cmp_eq_u32 s6, 0
    s_cbranch_scc0 L_nopoll_84
    s_mul_i32 s73, s71, 36
    v_add_u32 v4, s73, v1
    v_and_b32 v5, 7, v4
    v_lshlrev_b32 v5, 1, v5
    v_bfe_u32 v6, v4, 3, 1
    v_add_u32 v5, v5, v6
    v_lshlrev_b32 v5, 4, v5
    v_lshrrev_b32 v6, 4, v4
    v_add_u32 v3, v5, v6
    v_lshlrev_b32 v3, 7, v3
    v_add_u32 v3, 98304, v3
    s_mov_b32 exec_lo, -1
    s_mov_b32 exec_hi, 0xf
    s_mov_b32 s84, 0
L_poll_86:
    buffer_load_dwordx2 v[4:5], v3, s[40:43], 0 offen sc1
    s_add_u32 s84, s84, 1
    s_waitcnt vmcnt(0)
    v_cmp_ne_u32 vcc, s44, v4
    v_cmp_ne_u32 s[86:87], s45, v5
    s_nop 0
    s_or_b64 vcc, vcc, s[86:87]
    s_cmp_eq_u64 vcc, 0
    s_cbranch_scc1 L_polld_87
    s_cmp_gt_u32 s84, 20480
    s_cbranch_scc1 L_polld_87
    s_sleep 3
    s_branch L_poll_86
L_polld_87:
    s_mov_b64 exec, -1
    s_mov_b64 exec, 1
    v_mov_b32 v4, 162908
    v_mov_b32 v5, 1
    ds_add_u32 v4, v5
    s_mov_b64 exec, -1
    s_lshr_b32 s72, s70, 1
    v_lshlrev_b32 v3, 4, v1
    v_add_u32 v3, s72, v3
    v_lshlrev_b32 v3, 7, v3
    v_add_u32 v3, 32768, v3
    s_mov_b64 exec, 0xffff
    s_mov_b32 s84, 0
L_poll_88:
    buffer_load_dwordx2 v[4:5], v3, s[40:43], 0 offen sc1
    s_add_u32 s84, s84, 1
    s_waitcnt vmcnt(0)
    v_cmp_ne_u32 vcc, s44, v4
    v_cmp_ne_u32 s[86:87], s45, v5
    s_nop 0
    s_or_b64 vcc, vcc, s[86:87]
    s_cmp_eq_u64 vcc, 0
    s_cbranch_scc1 L_polld_89
    s_cmp_gt_u32 s84, 20480
    s_cbranch_scc1 L_polld_89
    s_sleep 3
    s_branch L_poll_88
L_polld_89:
    s_mov_b64 exec, -1
    s_mov_b64 exec, 1
    v_mov_b32 v4, 162912
    v_mov_b32 v5, 1
    ds_add_u32 v4, v5
    s_mov_b64 exec, -1
    s_branch L_go_85
L_nopoll_84:
    v_mov_b32 v4, 162908
    s_mov_b32 s85, 0
L_sp_90:
    ds_read_b32 v5, v4
    s_add_u32 s85, s85, 1
    s_waitcnt lgkmcnt(0)
    v_readfirstlane_b32 s84, v5
    s_nop 0
    s_cmp_ge_u32 s84, 1
    s_cbranch_scc1 L_spd_91
    s_cmp_gt_u32 s85, 1048576
    s_cbranch_scc1 L_spd_91
    s_sleep 1
    s_branch L_sp_90
L_spd_91:
    v_mov_b32 v4, 162912
    s_mov_b32 s85, 0
L_sp_92:
    ds_read_b32 v5, v4
    s_add_u32 s85, s85, 1
    s_waitcnt lgkmcnt(0)
    v_readfirstlane_b32 s84, v5
    s_nop 0
    s_cmp_ge_u32 s84, 1
    s_cbranch_scc1 L_spd_93
    s_cmp_gt_u32 s85, 1048576
    s_cbranch_scc1 L_spd_93
    s_sleep 1
    s_branch L_sp_92
L_spd_93:
L_go_85:
    s_setprio 1
    s_mul_i32 s78, s70, 224
    s_mul_i32 s75, s6, 28
    s_add_u32 s78, s78, s75
    s_lshl_b32 s78, s78, 10
    s_add_u32 s78, s78, 5242880
    s_add_u32 s80, s78, 114688
    s_mul_i32 s79, s71, 144
    s_add_u32 s81, s79, s75
    s_lshl_b32 s81, s81, 11
    s_add_u32 s81, s81, 14680064
    s_lshr_b32 s82, s2, 3
    s_lshl_b32 s83, s82, 10
    s_add_u32 s88, s78, s83
    s_add_u32 s89, s80, s83
    s_lshl_b32 s83, s82, 11
    s_add_u32 s90, s81, s83
    s_add_u32 s82, s82, 1
    s_cmp_ge_u32 s82, 28
    s_cselect_b32 s82, 0, s82
    buffer_load_dwordx4 v[8:11], v2, s[40:43], s88 offen sc1
    buffer_load_dwordx4 v[12:15], v2, s[40:43], s89 offen sc1
    buffer_load_dwordx4 v[16:19], v2, s[40:43], s90 offen sc1
    buffer_load_dwordx4 v[20:23], v2, s[40:43], s90 offen offset:1024 sc1
    s_lshl_b32 s83, s82, 10
    s_add_u32 s88, s78, s83
    s_add_u32 s89, s80, s83
    s_lshl_b32 s83, s82, 11
    s_add_u32 s90, s81, s83
    s_add_u32 s82, s82, 1
    s_cmp_ge_u32 s82, 28
    s_cselect_b32 s82, 0, s82
    buffer_load_dwordx4 v[24:27], v2, s[40:43], s88 offen sc1
    buffer_load_dwordx4 v[28:31], v2, s[40:43], s89 offen sc1
    buffer_load_dwordx4 v[32:35], v2, s[40:43], s90 offen sc1
    buffer_load_dwordx4 v[36:39], v2, s[40:43], s90 offen offset:1024 sc1
    s_waitcnt vmcnt(4)
    v_mfma_f32_32x32x16_bf16 v[104:119], v[16:19], v[8:11], 0
    v_mfma_f32_32x32x16_bf16 v[120:135], v[16:19], v[12:15], 0
    v_mfma_f32_32x32x16_bf16 v[136:151], v[20:23], v[8:11], 0
    v_mfma_f32_32x32x16_bf16 v[152:167], v[20:23], v[12:15], 0
    s_lshl_b32 s83, s82, 10
    s_add_u32 s88, s78, s83
    s_add_u32 s89, s80, s83
    s_lshl_b32 s83, s82, 11
    s_add_u32 s90, s81, s83
    s_add_u32 s82, s82, 1
    s_cmp_ge_u32 s82, 28
    s_cselect_b32 s82, 0, s82
    buffer_load_dwordx4 v[8:11], v2, s[40:43], s88 offen sc1
    buffer_load_dwordx4 v[12:15], v2, s[40:43], s89 offen sc1
    buffer_load_dwordx4 v[16:19], v2, s[40:43], s90 offen sc1
    buffer_load_dwordx4 v[20:23], v2, s[40:43], s90 offen offset:1024 sc1
    s_waitcnt vmcnt(4)
    v_mfma_f32_32x32x16_bf16 v[104:119], v[32:35], v[24:27], v[104:119]
    v_mfma_f32_32x32x16_bf16 v[120:135], v[32:35], v[28:31], v[120:135]
    v_mfma_f32_32x32x16_bf16 v[136:151], v[36:39], v[24:27], v[136:151]
    v_mfma_f32_32x32x16_bf16 v[152:167], v[36:39], v[28:31], v[152:167]
    s_lshl_b32 s83, s82, 10
    s_add_u32 s88, s78, s83
    s_add_u32 s89, s80, s83
    s_lshl_b32 s83, s82, 11
    s_add_u32 s90, s81, s83
    s_add_u32 s82, s82, 1
    s_cmp_ge_u32 s82, 28
    s_cselect_b32 s82, 0, s82
    buffer_load_dwordx4 v[24:27], v2, s[40:43], s88 offen sc1
    buffer_load_dwordx4 v[28:31], v2, s[40:43], s89 offen sc1
    buffer_load_dwordx4 v[32:35], v2, s[40:43], s90 offen sc1
    buffer_load_dwordx4 v[36:39], v2, s[40:43], s90 offen offset:1024 sc1
    s_waitcnt vmcnt(4)
    v_mfma_f32_32x32x16_bf16 v[104:119], v[16:19], v[8:11], v[104:119]
    v_mfma_f32_32x32x16_bf16 v[120:135], v[16:19], v[12:15], v[120:135]
    v_mfma_f32_32x32x16_bf16 v[136:151], v[20:23], v[8:11], v[136:151]
    v_mfma_f32_32x32x16_bf16 v[152:167], v[20:23], v[12:15], v[152:167]
    s_lshl_b32 s83, s82, 10
    s_add_u32 s88, s78, s83
    s_add_u32 s89, s80, s83
    s_lshl_b32 s83, s82, 11
    s_add_u32 s90, s81, s83
    s_add_u32 s82, s82, 1
    s_cmp_ge_u32 s82, 28
    s_cselect_b32 s82, 0, s82
    buffer_load_dwordx4 v[8:11], v2, s[40:43], s88 offen sc1
    buffer_load_dwordx4 v[12:15], v2, s[40:43], s89 offen sc1
    buffer_load_dwordx4 v[16:19], v2, s[40:43], s90 offen sc1
    buffer_load_dwordx4 v[20:23], v2, s[40:43], s90 offen offset:1024 sc1
    s_waitcnt vmcnt(4)
    v_mfma_f32_32x32x16_bf16 v[104:119], v[32:35], v[24:27], v[104:119]
    v_mfma_f32_32x32x16_bf16 v[120:135], v[32:35], v[28:31], v[120:135]
    v_mfma_f32_32x32x16_bf16 v[136:151], v[36:39], v[24:27], v[136:151]
    v_mfma_f32_32x32x16_bf16 v[152:167], v[36:39], v[28:31], v[152:167]
    s_lshl_b32 s83, s82, 10
    s_add_u32 s88, s78, s83
    s_add_u32 s89, s80, s83
    s_lshl_b32 s83, s82, 11
    s_add_u32 s90, s81, s83
    s_add_u32 s82, s82, 1
    s_cmp_ge_u32 s82, 28
    s_cselect_b32 s82, 0, s82
    buffer_load_dwordx4 v[24:27], v2, s[40:43], s88 offen sc1
    buffer_load_dwordx4 v[28:31], v2, s[40:43], s89 offen sc1
    buffer_load_dwordx4 v[32:35], v2, s[40:43], s90 offen sc1
    buffer_load_dwordx4 v[36:39], v2, s[40:43], s90 offen offset:1024 sc1
    s_waitcnt vmcnt(4)
    v_mfma_f32_32x32x16_bf16 v[104:119], v[16:19], v[8:11], v[104:119]
    v_mfma_f32_32x32x16_bf16 v[120:135], v[16:19], v[12:15], v[120:135]
    v_mfma_f32_32x32x16_bf16 v[136:151], v[20:23], v[8:11], v[136:151]
    v_mfma_f32_32x32x16_bf16 v[152:167], v[20:23], v[12:15], v[152:167]
    s_lshl_b32 s83, s82, 10
    s_add_u32 s88, s78, s83
    s_add_u32 s89, s80, s83
    s_lshl_b32 s83, s82, 11
    s_add_u32 s90, s81, s83
    s_add_u32 s82, s82, 1
    s_cmp_ge_u32 s82, 28
    s_cselect_b32 s82, 0, s82
    buffer_load_dwordx4 v[8:11], v2, s[40:43], s88 offen sc1
    buffer_load_dwordx4 v[12:15], v2, s[40:43], s89 offen sc1
    buffer_load_dwordx4 v[16:19], v2, s[40:43], s90 offen sc1
    buffer_load_dwordx4 v[20:23], v2, s[40:43], s90 offen offset:1024 sc1
    s_waitcnt vmcnt(4)
    v_mfma_f32_32x32x16_bf16 v[104:119], v[32:35], v[24:27], v[104:119]
    v_mfma_f32_32x32x16_bf16 v[120:135], v[32:35], v[28:31], v[120:135]
    v_mfma_f32_32x32x16_bf16 v[136:151], v[36:39], v[24:27], v[136:151]
    v_mfma_f32_32x32x16_bf16 v[152:167], v[36:39], v[28:31], v[152:167]
    s_lshl_b32 s83, s82, 10
    s_add_u32 s88, s78, s83
    s_add_u32 s89, s80, s83
    s_lshl_b32 s83, s82, 11
    s_add_u32 s90, s81, s83
    s_add_u32 s82, s82, 1
    s_cmp_ge_u32 s82, 28
    s_cselect_b32 s82, 0, s82
    buffer_load_dwordx4 v[24:27], v2, s[40:43], s88 offen sc1
    buffer_load_dwordx4 v[28:31], v2, s[40:43], s89 offen sc1
    buffer_load_dwordx4 v[32:35], v2, s[40:43], s90 offen sc1
    buffer_load_dwordx4 v[36:39], v2, s[40:43], s90 offen offset:1024 sc1
    s_waitcnt vmcnt(4)
    v_mfma_f32_32x32x16_bf16 v[104:119], v[16:19], v[8:11], v[104:119]
    v_mfma_f32_32x32x16_bf16 v[120:135], v[16:19], v[12:15], v[120:135]
    v_mfma_f32_32x32x16_bf16 v[136:151], v[20:23], v[8:11], v[136:151]
    v_mfma_f32_32x32x16_bf16 v[152:167], v[20:23], v[12:15], v[152:167]
    s_lshl_b32 s83, s82, 10
    s_add_u32 s88, s78, s83
    s_add_u32 s89, s80, s83
    s_lshl_b32 s83, s82, 11
    s_add_u32 s90, s81, s83
    s_add_u32 s82, s82, 1
    s_cmp_ge_u32 s82, 28
    s_cselect_b32 s82, 0, s82
    buffer_load_dwordx4 v[8:11], v2, s[40:43], s88 offen sc1
    buffer_load_dwordx4 v[12:15], v2, s[40:43], s89 offen sc1
    buffer_load_dwordx4 v[16:19], v2, s[40:43], s90 offen sc1
    buffer_load_dwordx4 v[20:23], v2, s[40:43], s90 offen offset:1024 sc1
    s_waitcnt vmcnt(4)
    v_mfma_f32_32x32x16_bf16 v[104:119], v[32:35], v[24:27], v[104:119]
    v_mfma_f32_32x32x16_bf16 v[120:135], v[32:35], v[28:31], v[120:135]
    v_mfma_f32_32x32x16_bf16 v[136:151], v[36:39], v[24:27], v[136:151]
    v_mfma_f32_32x32x16_bf16 v[152:167], v[36:39], v[28:31], v[152:167]
    s_lshl_b32 s83, s82, 10
    s_add_u32 s88, s78, s83
    s_add_u32 s89, s80, s83
    s_lshl_b32 s83, s82, 11
    s_add_u32 s90, s81, s83
    s_add_u32 s82, s82, 1
    s_cmp_ge_u32 s82, 28
    s_cselect_b32 s82, 0, s82
    buffer_load_dwordx4 v[24:27], v2, s[40:43], s88 offen sc1
    buffer_load_dwordx4 v[28:31], v2, s[40:43], s89 offen sc1
    buffer_load_dwordx4 v[32:35], v2, s[40:43], s90 offen sc1
    buffer_load_dwordx4 v[36:39], v2, s[40:43], s90 offen offset:1024 sc1
    s_waitcnt vmcnt(4)
    v_mfma_f32_32x32x16_bf16 v[104:119], v[16:19], v[8:11], v[104:119]
    v_mfma_f32_32x32x16_bf16 v[120:135], v[16:19], v[12:15], v[120:135]
    v_mfma_f32_32x32x16_bf16 v[136:151], v[20:23], v[8:11], v[136:151]
    v_mfma_f32_32x32x16_bf16 v[152:167], v[20:23], v[12:15], v[152:167]
    s_lshl_b32 s83, s82, 10
    s_add_u32 s88, s78, s83
    s_add_u32 s89, s80, s83
    s_lshl_b32 s83, s82, 11
    s_add_u32 s90, s81, s83
    s_add_u32 s82, s82, 1
    s_cmp_ge_u32 s82, 28
    s_cselect_b32 s82, 0, s82
    buffer_load_dwordx4 v[8:11], v2, s[40:43], s88 offen sc1
    buffer_load_dwordx4 v[12:15], v2, s[40:43], s89 offen sc1
    buffer_load_dwordx4 v[16:19], v2, s[40:43], s90 offen sc1
    buffer_load_dwordx4 v[20:23], v2, s[40:43], s90 offen offset:1024 sc1
    s_waitcnt vmcnt(4)
    v_mfma_f32_32x32x16_bf16 v[104:119], v[32:35], v[24:27], v[104:119]
    v_mfma_f32_32x32x16_bf16 v[120:135], v[32:35], v[28:31], v[120:135]
    v_mfma_f32_32x32x16_bf16 v[136:151], v[36:39], v[24:27], v[136:151]
    v_mfma_f32_32x32x16_bf16 v[152:167], v[36:39], v[28:31], v[152:167]
    s_lshl_b32 s83, s82, 10
    s_add_u32 s88, s78, s83
    s_add_u32 s89, s80, s83
    s_lshl_b32 s83, s82, 11
    s_add_u32 s90, s81, s83
    s_add_u32 s82, s82, 1
    s_cmp_ge_u32 s82, 28
    s_cselect_b32 s82, 0, s82
    buffer_load_dwordx4 v[24:27], v2, s[40:43], s88 offen sc1
    buffer_load_dwordx4 v[28:31], v2, s[40:43], s89 offen sc1
    buffer_load_dwordx4 v[32:35], v2, s[40:43], s90 offen sc1
    buffer_load_dwordx4 v[36:39], v2, s[40:43], s90 offen offset:1024 sc1
    s_waitcnt vmcnt(4)
    v_mfma_f32_32x32x16_bf16 v[104:119], v[16:19], v[8:11], v[104:119]
    v_mfma_f32_32x32x16_bf16 v[120:135], v[16:19], v[12:15], v[120:135]
    v_mfma_f32_32x32x16_bf16 v[136:151], v[20:23], v[8:11], v[136:151]
    v_mfma_f32_32x32x16_bf16 v[152:167], v[20:23], v[12:15], v[152:167]
    s_lshl_b32 s83, s82, 10
    s_add_u32 s88, s78, s83
    s_add_u32 s89, s80, s83
    s_lshl_b32 s83, s82, 11
    s_add_u32 s90, s81, s83
    s_add_u32 s82, s82, 1
    s_cmp_ge_u32 s82, 28
    s_cselect_b32 s82, 0, s82
    buffer_load_dwordx4 v[8:11], v2, s[40:43], s88 offen sc1
    buffer_load_dwordx4 v[12:15], v2, s[40:43], s89 offen sc1
    buffer_load_dwordx4 v[16:19], v2, s[40:43], s90 offen sc1
    buffer_load_dwordx4 v[20:23], v2, s[40:43], s90 offen offset:1024 sc1
    s_waitcnt vmcnt(4)
    v_mfma_f32_32x32x16_bf16 v[104:119], v[32:35], v[24:27], v[104:119]
    v_mfma_f32_32x32x16_bf16 v[120:135], v[32:35], v[28:31], v[120:135]
    v_mfma_f32_32x32x16_bf16 v[136:151], v[36:39], v[24:27], v[136:151]
    v_mfma_f32_32x32x16_bf16 v[152:167], v[36:39], v[28:31], v[152:167]
    s_lshl_b32 s83, s82, 10
    s_add_u32 s88, s78, s83
    s_add_u32 s89, s80, s83
    s_lshl_b32 s83, s82, 11
    s_add_u32 s90, s81, s83
    s_add_u32 s82, s82, 1
    s_cmp_ge_u32 s82, 28
    s_cselect_b32 s82, 0, s82
    buffer_load_dwordx4 v[24:27], v2, s[40:43], s88 offen sc1
    buffer_load_dwordx4 v[28:31], v2, s[40:43], s89 offen sc1
    buffer_load_dwordx4 v[32:35], v2, s[40:43], s90 offen sc1
    buffer_load_dwordx4 v[36:39], v2, s[40:43], s90 offen offset:1024 sc1
    s_waitcnt vmcnt(4)
    v_mfma_f32_32x32x16_bf16 v[104:119], v[16:19], v[8:11], v[104:119]
    v_mfma_f32_32x32x16_bf16 v[120:135], v[16:19], v[12:15], v[120:135]
    v_mfma_f32_32x32x16_bf16 v[136:151], v[20:23], v[8:11], v[136:151]
    v_mfma_f32_32x32x16_bf16 v[152:167], v[20:23], v[12:15], v[152:167]
    s_lshl_b32 s83, s82, 10
    s_add_u32 s88, s78, s83
    s_add_u32 s89, s80, s83
    s_lshl_b32 s83, s82, 11
    s_add_u32 s90, s81, s83
    s_add_u32 s82, s82, 1
    s_cmp_ge_u32 s82, 28
    s_cselect_b32 s82, 0, s82
    buffer_load_dwordx4 v[8:11], v2, s[40:43], s88 offen sc1
    buffer_load_dwordx4 v[12:15], v2, s[40:43], s89 offen sc1
    buffer_load_dwordx4 v[16:19], v2, s[40:43], s90 offen sc1
    buffer_load_dwordx4 v[20:23], v2, s[40:43], s90 offen offset:1024 sc1
    s_waitcnt vmcnt(4)
    v_mfma_f32_32x32x16_bf16 v[104:119], v[32:35], v[24:27], v[104:119]
    v_mfma_f32_32x32x16_bf16 v[120:135], v[32:35], v[28:31], v[120:135]
    v_mfma_f32_32x32x16_bf16 v[136:151], v[36:39], v[24:27], v[136:151]
    v_mfma_f32_32x32x16_bf16 v[152:167], v[36:39], v[28:31], v[152:167]
    s_lshl_b32 s83, s82, 10
    s_add_u32 s88, s78, s83
    s_add_u32 s89, s80, s83
    s_lshl_b32 s83, s82, 11
    s_add_u32 s90, s81, s83
    s_add_u32 s82, s82, 1
    s_cmp_ge_u32 s82, 28
    s_cselect_b32 s82, 0, s82
    buffer_load_dwordx4 v[24:27], v2, s[40:43], s88 offen sc1
    buffer_load_dwordx4 v[28:31], v2, s[40:43], s89 offen sc1
    buffer_load_dwordx4 v[32:35], v2, s[40:43], s90 offen sc1
    buffer_load_dwordx4 v[36:39], v2, s[40:43], s90 offen offset:1024 sc1
    s_waitcnt vmcnt(4)
    v_mfma_f32_32x32x16_bf16 v[104:119], v[16:19], v[8:11], v[104:119]
    v_mfma_f32_32x32x16_bf16 v[120:135], v[16:19], v[12:15], v[120:135]
    v_mfma_f32_32x32x16_bf16 v[136:151], v[20:23], v[8:11], v[136:151]
    v_mfma_f32_32x32x16_bf16 v[152:167], v[20:23], v[12:15], v[152:167]
    s_lshl_b32 s83, s82, 10
    s_add_u32 s88, s78, s83
    s_add_u32 s89, s80, s83
    s_lshl_b32 s83, s82, 11
    s_add_u32 s90, s81, s83
    s_add_u32 s82, s82, 1
    s_cmp_ge_u32 s82, 28
    s_cselect_b32 s82, 0, s82
    buffer_load_dwordx4 v[8:11], v2, s[40:43], s88 offen sc1
    buffer_load_dwordx4 v[12:15], v2, s[40:43], s89 offen sc1
    buffer_load_dwordx4 v[16:19], v2, s[40:43], s90 offen sc1
    buffer_load_dwordx4 v[20:23], v2, s[40:43], s90 offen offset:1024 sc1
    s_waitcnt vmcnt(4)
    v_mfma_f32_32x32x16_bf16 v[104:119], v[32:35], v[24:27], v[104:119]
    v_mfma_f32_32x32x16_bf16 v[120:135], v[32:35], v[28:31], v[120:135]
    v_mfma_f32_32x32x16_bf16 v[136:151], v[36:39], v[24:27], v[136:151]
    v_mfma_f32_32x32x16_bf16 v[152:167], v[36:39], v[28:31], v[152:167]
    s_lshl_b32 s83, s82, 10
    s_add_u32 s88, s78, s83
    s_add_u32 s89, s80, s83
    s_lshl_b32 s83, s82, 11
    s_add_u32 s90, s81, s83
    s_add_u32 s82, s82, 1
    s_cmp_ge_u32 s82, 28
    s_cselect_b32 s82, 0, s82
    buffer_load_dwordx4 v[24:27], v2, s[40:43], s88 offen sc1
    buffer_load_dwordx4 v[28:31], v2, s[40:43], s89 offen sc1
    buffer_load_dwordx4 v[32:35], v2, s[40:43], s90 offen sc1
    buffer_load_dwordx4 v[36:39], v2, s[40:43], s90 offen offset:1024 sc1
    s_waitcnt vmcnt(4)
    v_mfma_f32_32x32x16_bf16 v[104:119], v[16:19], v[8:11], v[104:119]
    v_mfma_f32_32x32x16_bf16 v[120:135], v[16:19], v[12:15], v[120:135]
    v_mfma_f32_32x32x16_bf16 v[136:151], v[20:23], v[8:11], v[136:151]
    v_mfma_f32_32x32x16_bf16 v[152:167], v[20:23], v[12:15], v[152:167]
    s_lshl_b32 s83, s82, 10
    s_add_u32 s88, s78, s83
    s_add_u32 s89, s80, s83
    s_lshl_b32 s83, s82, 11
    s_add_u32 s90, s81, s83
    s_add_u32 s82, s82, 1
    s_cmp_ge_u32 s82, 28
    s_cselect_b32 s82, 0, s82
    buffer_load_dwordx4 v[8:11], v2, s[40:43], s88 offen sc1
    buffer_load_dwordx4 v[12:15], v2, s[40:43], s89 offen sc1
    buffer_load_dwordx4 v[16:19], v2, s[40:43], s90 offen sc1
    buffer_load_dwordx4 v[20:23], v2, s[40:43], s90 offen offset:1024 sc1
    s_waitcnt vmcnt(4)
    v_mfma_f32_32x32x16_bf16 v[104:119], v[32:35], v[24:27], v[104:119]
    v_mfma_f32_32x32x16_bf16 v[120:135], v[32:35], v[28:31], v[120:135]
    v_mfma_f32_32x32x16_bf16 v[136:151], v[36:39], v[24:27], v[136:151]
    v_mfma_f32_32x32x16_bf16 v[152:167], v[36:39], v[28:31], v[152:167]
    s_lshl_b32 s83, s82, 10
    s_add_u32 s88, s78, s83
    s_add_u32 s89, s80, s83
    s_lshl_b32 s83, s82, 11
    s_add_u32 s90, s81, s83
    s_add_u32 s82, s82, 1
    s_cmp_ge_u32 s82, 28
    s_cselect_b32 s82, 0, s82
    buffer_load_dwordx4 v[24:27], v2, s[40:43], s88 offen sc1
    buffer_load_dwordx4 v[28:31], v2, s[40:43], s89 offen sc1
    buffer_load_dwordx4 v[32:35], v2, s[40:43], s90 offen sc1
    buffer_load_dwordx4 v[36:39], v2, s[40:43], s90 offen offset:1024 sc1
    s_waitcnt vmcnt(4)
    v_mfma_f32_32x32x16_bf16 v[104:119], v[16:19], v[8:11], v[104:119]
    v_mfma_f32_32x32x16_bf16 v[120:135], v[16:19], v[12:15], v[120:135]
    v_mfma_f32_32x32x16_bf16 v[136:151], v[20:23], v[8:11], v[136:151]
    v_mfma_f32_32x32x16_bf16 v[152:167], v[20:23], v[12:15], v[152:167]
    s_lshl_b32 s83, s82, 10
    s_add_u32 s88, s78, s83
    s_add_u32 s89, s80, s83
    s_lshl_b32 s83, s82, 11
    s_add_u32 s90, s81, s83
    s_add_u32 s82, s82, 1
    s_cmp_ge_u32 s82, 28
    s_cselect_b32 s82, 0, s82
    buffer_load_dwordx4 v[8:11], v2, s[40:43], s88 offen sc1
    buffer_load_dwordx4 v[12:15], v2, s[40:43], s89 offen sc1
    buffer_load_dwordx4 v[16:19], v2, s[40:43], s90 offen sc1
    buffer_load_dwordx4 v[20:23], v2, s[40:43], s90 offen offset:1024 sc1
    s_waitcnt vmcnt(4)
    v_mfma_f32_32x32x16_bf16 v[104:119], v[32:35], v[24:27], v[104:119]
    v_mfma_f32_32x32x16_bf16 v[120:135], v[32:35], v[28:31], v[120:135]
    v_mfma_f32_32x32x16_bf16 v[136:151], v[36:39], v[24:27], v[136:151]
    v_mfma_f32_32x32x16_bf16 v[152:167], v[36:39], v[28:31], v[152:167]
    s_lshl_b32 s83, s82, 10
    s_add_u32 s88, s78, s83
    s_add_u32 s89, s80, s83
    s_lshl_b32 s83, s82, 11
    s_add_u32 s90, s81, s83
    s_add_u32 s82, s82, 1
    s_cmp_ge_u32 s82, 28
    s_cselect_b32 s82, 0, s82
    buffer_load_dwordx4 v[24:27], v2, s[40:43], s88 offen sc1
    buffer_load_dwordx4 v[28:31], v2, s[40:43], s89 offen sc1
    buffer_load_dwordx4 v[32:35], v2, s[40:43], s90 offen sc1
    buffer_load_dwordx4 v[36:39], v2, s[40:43], s90 offen offset:1024 sc1
    s_waitcnt vmcnt(4)
    v_mfma_f32_32x32x16_bf16 v[104:119], v[16:19], v[8:11], v[104:119]
    v_mfma_f32_32x32x16_bf16 v[120:135], v[16:19], v[12:15], v[120:135]
    v_mfma_f32_32x32x16_bf16 v[136:151], v[20:23], v[8:11], v[136:151]
    v_mfma_f32_32x32x16_bf16 v[152:167], v[20:23], v[12:15], v[152:167]
    s_lshl_b32 s83, s82, 10
    s_add_u32 s88, s78, s83
    s_add_u32 s89, s80, s83
    s_lshl_b32 s83, s82, 11
    s_add_u32 s90, s81, s83
    s_add_u32 s82, s82, 1
    s_cmp_ge_u32 s82, 28
    s_cselect_b32 s82, 0, s82
    buffer_load_dwordx4 v[8:11], v2, s[40:43], s88 offen sc1
    buffer_load_dwordx4 v[12:15], v2, s[40:43], s89 offen sc1
    buffer_load_dwordx4 v[16:19], v2, s[40:43], s90 offen sc1
    buffer_load_dwordx4 v[20:23], v2, s[40:43], s90 offen offset:1024 sc1
    s_waitcnt vmcnt(4)
    v_mfma_f32_32x32x16_bf16 v[104:119], v[32:35], v[24:27], v[104:119]
    v_mfma_f32_32x32x16_bf16 v[120:135], v[32:35], v[28:31], v[120:135]
    v_mfma_f32_32x32x16_bf16 v[136:151], v[36:39], v[24:27], v[136:151]
    v_mfma_f32_32x32x16_bf16 v[152:167], v[36:39], v[28:31], v[152:167]
    s_lshl_b32 s83, s82, 10
    s_add_u32 s88, s78, s83
    s_add_u32 s89, s80, s83
    s_lshl_b32 s83, s82, 11
    s_add_u32 s90, s81, s83
    s_add_u32 s82, s82, 1
    s_cmp_ge_u32 s82, 28
    s_cselect_b32 s82, 0, s82
    buffer_load_dwordx4 v[24:27], v2, s[40:43], s88 offen sc1
    buffer_load_dwordx4 v[28:31], v2, s[40:43], s89 offen sc1
    buffer_load_dwordx4 v[32:35], v2, s[40:43], s90 offen sc1
    buffer_load_dwordx4 v[36:39], v2, s[40:43], s90 offen offset:1024 sc1
    s_waitcnt vmcnt(4)
    v_mfma_f32_32x32x16_bf16 v[104:119], v[16:19], v[8:11], v[104:119]
    v_mfma_f32_32x32x16_bf16 v[120:135], v[16:19], v[12:15], v[120:135]
    v_mfma_f32_32x32x16_bf16 v[136:151], v[20:23], v[8:11], v[136:151]
    v_mfma_f32_32x32x16_bf16 v[152:167], v[20:23], v[12:15], v[152:167]
    s_lshl_b32 s83, s82, 10
    s_add_u32 s88, s78, s83
    s_add_u32 s89, s80, s83
    s_lshl_b32 s83, s82, 11
    s_add_u32 s90, s81, s83
    s_add_u32 s82, s82, 1
    s_cmp_ge_u32 s82, 28
    s_cselect_b32 s82, 0, s82
    buffer_load_dwordx4 v[8:11], v2, s[40:43], s88 offen sc1
    buffer_load_dwordx4 v[12:15], v2, s[40:43], s89 offen sc1
    buffer_load_dwordx4 v[16:19], v2, s[40:43], s90 offen sc1
    buffer_load_dwordx4 v[20:23], v2, s[40:43], s90 offen offset:1024 sc1
    s_waitcnt vmcnt(4)
    v_mfma_f32_32x32x16_bf16 v[104:119], v[32:35], v[24:27], v[104:119]
    v_mfma_f32_32x32x16_bf16 v[120:135], v[32:35], v[28:31], v[120:135]
    v_mfma_f32_32x32x16_bf16 v[136:151], v[36:39], v[24:27], v[136:151]
    v_mfma_f32_32x32x16_bf16 v[152:167], v[36:39], v[28:31], v[152:167]
    s_lshl_b32 s83, s82, 10
    s_add_u32 s88, s78, s83
    s_add_u32 s89, s80, s83
    s_lshl_b32 s83, s82, 11
    s_add_u32 s90, s81, s83
    s_add_u32 s82, s82, 1
    s_cmp_ge_u32 s82, 28
    s_cselect_b32 s82, 0, s82
    buffer_load_dwordx4 v[24:27], v2, s[40:43], s88 offen sc1
    buffer_load_dwordx4 v[28:31], v2, s[40:43], s89 offen sc1
    buffer_load_dwordx4 v[32:35], v2, s[40:43], s90 offen sc1
    buffer_load_dwordx4 v[36:39], v2, s[40:43], s90 offen offset:1024 sc1
    s_waitcnt vmcnt(4)
    v_mfma_f32_32x32x16_bf16 v[104:119], v[16:19], v[8:11], v[104:119]
    v_mfma_f32_32x32x16_bf16 v[120:135], v[16:19], v[12:15], v[120:135]
    v_mfma_f32_32x32x16_bf16 v[136:151], v[20:23], v[8:11], v[136:151]
    v_mfma_f32_32x32x16_bf16 v[152:167], v[20:23], v[12:15], v[152:167]
    s_lshl_b32 s83, s82, 10
    s_add_u32 s88, s78, s83
    s_add_u32 s89, s80, s83
    s_lshl_b32 s83, s82, 11
    s_add_u32 s90, s81, s83
    s_add_u32 s82, s82, 1
    s_cmp_ge_u32 s82, 28
    s_cselect_b32 s82, 0, s82
    buffer_load_dwordx4 v[8:11], v2, s[40:43], s88 offen sc1
    buffer_load_dwordx4 v[12:15], v2, s[40:43], s89 offen sc1
    buffer_load_dwordx4 v[16:19], v2, s[40:43], s90 offen sc1
    buffer_load_dwordx4 v[20:23], v2, s[40:43], s90 offen offset:1024 sc1
    s_waitcnt vmcnt(4)
    v_mfma_f32_32x32x16_bf16 v[104:119], v[32:35], v[24:27], v[104:119]
    v_mfma_f32_32x32x16_bf16 v[120:135], v[32:35], v[28:31], v[120:135]
    v_mfma_f32_32x32x16_bf16 v[136:151], v[36:39], v[24:27], v[136:151]
    v_mfma_f32_32x32x16_bf16 v[152:167], v[36:39], v[28:31], v[152:167]
    s_lshl_b32 s83, s82, 10
    s_add_u32 s88, s78, s83
    s_add_u32 s89, s80, s83
    s_lshl_b32 s83, s82, 11
    s_add_u32 s90, s81, s83
    s_add_u32 s82, s82, 1
    s_cmp_ge_u32 s82, 28
    s_cselect_b32 s82, 0, s82
    buffer_load_dwordx4 v[24:27], v2, s[40:43], s88 offen sc1
    buffer_load_dwordx4 v[28:31], v2, s[40:43], s89 offen sc1
    buffer_load_dwordx4 v[32:35], v2, s[40:43], s90 offen sc1
    buffer_load_dwordx4 v[36:39], v2, s[40:43], s90 offen offset:1024 sc1
    s_waitcnt vmcnt(4)
    v_mfma_f32_32x32x16_bf16 v[104:119], v[16:19], v[8:11], v[104:119]
    v_mfma_f32_32x32x16_bf16 v[120:135], v[16:19], v[12:15], v[120:135]
    v_mfma_f32_32x32x16_bf16 v[136:151], v[20:23], v[8:11], v[136:151]
    v_mfma_f32_32x32x16_bf16 v[152:167], v[20:23], v[12:15], v[152:167]
    s_waitcnt vmcnt(0)
    v_mfma_f32_32x32x16_bf16 v[104:119], v[32:35], v[24:27], v[104:119]
    v_mfma_f32_32x32x16_bf16 v[120:135], v[32:35], v[28:31], v[120:135]
    v_mfma_f32_32x32x16_bf16 v[136:151], v[36:39], v[24:27], v[136:151]
    v_mfma_f32_32x32x16_bf16 v[152:167], v[36:39], v[28:31], v[152:167]
    s_setprio 3
    s_lshr_b32 s75, s6, 1
    s_and_b32 s76, s6, 1
    s_lshl_b32 s77, s70, 6
    s_lshl_b32 s82, s76, 5
    s_add_u32 s77, s77, s82
    v_and_b32 v3, 31, v1
    v_add_u32 v3, s77, v3
    v_mul_u32_u24 v3, 896, v3
    v_lshrrev_b32 v4, 5, v1
    v_lshl_add_u32 v5, v4, 3, v3
    v_lshl_add_u32 v3, v4, 4, v3
    v_lshlrev_b32 v6, 3, v4
    s_lshl_b32 s77, s71, 7
    s_lshl_b32 s82, s75, 6
    s_add_u32 s77, s77, s82
    buffer_load_dwordx2 v[40:41], v5, s[8:11], s77 offen offset:0
    buffer_load_dwordx2 v[48:49], v6, s[32:35], s77 offen offset:0
    buffer_load_dwordx2 v[42:43], v5, s[8:11], s77 offen offset:16
    buffer_load_dwordx2 v[50:51], v6, s[32:35], s77 offen offset:16
    buffer_load_dwordx2 v[44:45], v5, s[8:11], s77 offen offset:32
    buffer_load_dwordx2 v[52:53], v6, s[32:35], s77 offen offset:32
    buffer_load_dwordx2 v[46:47], v5, s[8:11], s77 offen offset:48
    buffer_load_dwordx2 v[54:55], v6, s[32:35], s77 offen offset:48
    s_lshl_b32 s75, s6, 3
    s_add_u32 s81, s79, s75
    s_add_u32 s81, s81, 112
    s_lshl_b32 s81, s81, 11
    s_add_u32 s81, s81, 14680064
    buffer_load_dwordx4 v[8:11], v2, s[40:43], s81 offen sc1
    buffer_load_dwordx4 v[12:15], v2, s[40:43], s81 offen offset:1024 sc1
    s_add_u32 s81, s81, 2048
    buffer_load_dwordx4 v[16:19], v2, s[40:43], s81 offen sc1
    buffer_load_dwordx4 v[20:23], v2, s[40:43], s81 offen offset:1024 sc1
    s_add_u32 s81, s81, 2048
    buffer_load_dwordx4 v[24:27], v2, s[40:43], s81 offen sc1
    buffer_load_dwordx4 v[28:31], v2, s[40:43], s81 offen offset:1024 sc1
    s_add_u32 s81, s81, 2048
    buffer_load_dwordx4 v[32:35], v2, s[40:43], s81 offen sc1
    buffer_load_dwordx4 v[36:39], v2, s[40:43], s81 offen offset:1024 sc1
    s_add_u32 s81, s81, 2048
    s_waitcnt vmcnt(8)
    v_lshlrev_b32 v56, 16, v40
    v_and_b32 v57, 0xffff0000, v40
    v_lshlrev_b32 v88, 16, v48
    v_and_b32 v89, 0xffff0000, v48
    v_add_f32 v56, v56, v88
    v_add_f32 v57, v57, v89
    v_lshlrev_b32 v58, 16, v41
    v_and_b32 v59, 0xffff0000, v41
    v_lshlrev_b32 v88, 16, v49
    v_and_b32 v89, 0xffff0000, v49
    v_add_f32 v58, v58, v88
    v_add_f32 v59, v59, v89
    v_lshlrev_b32 v60, 16, v42
    v_and_b32 v61, 0xffff0000, v42
    v_lshlrev_b32 v88, 16, v50
    v_and_b32 v89, 0xffff0000, v50
    v_add_f32 v60, v60, v88
    v_add_f32 v61, v61, v89
    v_lshlrev_b32 v62, 16, v43
    v_and_b32 v63, 0xffff0000, v43
    v_lshlrev_b32 v88, 16, v51
    v_and_b32 v89, 0xffff0000, v51
    v_add_f32 v62, v62, v88
    v_add_f32 v63, v63, v89
    v_lshlrev_b32 v64, 16, v44
    v_and_b32 v65, 0xffff0000, v44
    v_lshlrev_b32 v88, 16, v52
    v_and_b32 v89, 0xffff0000, v52
    v_add_f32 v64, v64, v88
    v_add_f32 v65, v65, v89
    v_lshlrev_b32 v66, 16, v45
    v_and_b32 v67, 0xffff0000, v45
    v_lshlrev_b32 v88, 16, v53
    v_and_b32 v89, 0xffff0000, v53
    v_add_f32 v66, v66, v88
    v_add_f32 v67, v67, v89
    v_lshlrev_b32 v68, 16, v46
    v_and_b32 v69, 0xffff0000, v46
    v_lshlrev_b32 v88, 16, v54
    v_and_b32 v89, 0xffff0000, v54
    v_add_f32 v68, v68, v88
    v_add_f32 v69, v69, v89
    v_lshlrev_b32 v70, 16, v47
    v_and_b32 v71, 0xffff0000, v47
    v_lshlrev_b32 v88, 16, v55
    v_and_b32 v89, 0xffff0000, v55
    v_add_f32 v70, v70, v88
    v_add_f32 v71, v71, v89
    s_cmp_eq_u32 s6, 0
    s_cbranch_scc0 L_pa_95
    v_add_f32 v104, v104, v56
    v_add_f32 v105, v105, v57
    v_add_f32 v106, v106, v58
    v_add_f32 v107, v107, v59
    v_add_f32 v108, v108, v60
    v_add_f32 v109, v109, v61
    v_add_f32 v110, v110, v62
    v_add_f32 v111, v111, v63
    v_add_f32 v112, v112, v64
    v_add_f32 v113, v113, v65
    v_add_f32 v114, v114, v66
    v_add_f32 v115, v115, v67
    v_add_f32 v116, v116, v68
    v_add_f32 v117, v117, v69
    v_add_f32 v118, v118, v70
    v_add_f32 v119, v119, v71
    s_branch L_paj_98
L_pa_95:
    s_cmp_eq_u32 s6, 1
    s_cbranch_scc0 L_pa_96
    v_add_f32 v120, v120, v56
    v_add_f32 v121, v121, v57
    v_add_f32 v122, v122, v58
    v_add_f32 v123, v123, v59
    v_add_f32 v124, v124, v60
    v_add_f32 v125, v125, v61
    v_add_f32 v126, v126, v62
    v_add_f32 v127, v127, v63
    v_add_f32 v128, v128, v64
    v_add_f32 v129, v129, v65
    v_add_f32 v130, v130, v66
    v_add_f32 v131, v131, v67
    v_add_f32 v132, v132, v68
    v_add_f32 v133, v133, v69
    v_add_f32 v134, v134, v70
    v_add_f32 v135, v135, v71
    s_branch L_paj_98
L_pa_96:
    s_cmp_eq_u32 s6, 2
    s_cbranch_scc0 L_pa_97
    v_add_f32 v136, v136, v56
    v_add_f32 v137, v137, v57
    v_add_f32 v138, v138, v58
    v_add_f32 v139, v139, v59
    v_add_f32 v140, v140, v60
    v_add_f32 v141, v141, v61
    v_add_f32 v142, v142, v62
    v_add_f32 v143, v143, v63
    v_add_f32 v144, v144, v64
    v_add_f32 v145, v145, v65
    v_add_f32 v146, v146, v66
    v_add_f32 v147, v147, v67
    v_add_f32 v148, v148, v68
    v_add_f32 v149, v149, v69
    v_add_f32 v150, v150, v70
    v_add_f32 v151, v151, v71
    s_branch L_paj_98
L_pa_97:
    v_add_f32 v152, v152, v56
    v_add_f32 v153, v153, v57
    v_add_f32 v154, v154, v58
    v_add_f32 v155, v155, v59
    v_add_f32 v156, v156, v60
    v_add_f32 v157, v157, v61
    v_add_f32 v158, v158, v62
    v_add_f32 v159, v159, v63
    v_add_f32 v160, v160, v64
    v_add_f32 v161, v161, v65
    v_add_f32 v162, v162, v66
    v_add_f32 v163, v163, v67
    v_add_f32 v164, v164, v68
    v_add_f32 v165, v165, v69
    v_add_f32 v166, v166, v70
    v_add_f32 v167, v167, v71
L_paj_98:
    s_lshl_b32 s78, s70, 6
    s_add_u32 s78, s78, s75
    s_lshl_b32 s78, s78, 10
    s_add_u32 s78, s78, 12582912
    s_add_u32 s80, s78, 32768
    s_lshl_b32 s83, s6, 2
    v_mov_b32 v7, 162900
    s_mov_b32 s85, 0
L_om_99:
    ds_read_b32 v6, v7
    s_add_u32 s85, s85, 1
    s_waitcnt lgkmcnt(0)
    v_readfirstlane_b32 s84, v6
    s_nop 0
    s_lshr_b32 s84, s84, s83
    s_bitcmp1_b32 s84, 0
    s_cbranch_scc1 L_omd_100
    s_cmp_gt_u32 s85, 1048576
    s_cbranch_scc1 L_omd_100
    s_sleep 1
    s_branch L_om_99
L_omd_100:
    buffer_load_dwordx4 v[40:43], v2, s[40:43], s78 offen sc1
    buffer_load_dwordx4 v[44:47], v2, s[40:43], s80 offen sc1
    s_add_u32 s78, s78, 1024
    s_add_u32 s80, s80, 1024
    buffer_load_dwordx4 v[48:51], v2, s[40:43], s78 offen sc1
    buffer_load_dwordx4 v[52:55], v2, s[40:43], s80 offen sc1
    s_add_u32 s78, s78, 1024
    s_add_u32 s80, s80, 1024
    s_mov_b32 s85, 0
L_om_101:
    ds_read_b32 v6, v7
    s_add_u32 s85, s85, 1
    s_waitcnt lgkmcnt(0)
    v_readfirstlane_b32 s84, v6
    s_nop 0
    s_lshr_b32 s84, s84, s83
    s_bitcmp1_b32 s84, 1
    s_cbranch_scc1 L_omd_102
    s_cmp_gt_u32 s85, 1048576
    s_cbranch_scc1 L_omd_102
    s_sleep 1
    s_branch L_om_101
L_omd_102:
    buffer_load_dwordx4 v[56:59], v2, s[40:43], s78 offen sc1
    buffer_load_dwordx4 v[60:63], v2, s[40:43], s80 offen sc1
    s_add_u32 s78, s78, 1024
    s_add_u32 s80, s80, 1024
    buffer_load_dwordx4 v[64:67], v2, s[40:43], s78 offen sc1
    buffer_load_dwordx4 v[68:71], v2, s[40:43], s80 offen sc1
    s_add_u32 s78, s78, 1024
    s_add_u32 s80, s80, 1024
    s_waitcnt vmcnt(6)
    v_mfma_f32_32x32x16_bf16 v[104:119], v[8:11], v[40:43], v[104:119]
    v_mfma_f32_32x32x16_bf16 v[120:135], v[8:11], v[44:47], v[120:135]
    v_mfma_f32_32x32x16_bf16 v[136:151], v[12:15], v[40:43], v[136:151]
    v_mfma_f32_32x32x16_bf16 v[152:167], v[12:15], v[44:47], v[152:167]
    buffer_load_dwordx4 v[8:11], v2, s[40:43], s81 offen sc1
    buffer_load_dwordx4 v[12:15], v2, s[40:43], s81 offen offset:1024 sc1
    s_add_u32 s81, s81, 2048
    s_waitcnt vmcnt(6)
    v_mfma_f32_32x32x16_bf16 v[104:119], v[16:19], v[48:51], v[104:119]
    v_mfma_f32_32x32x16_bf16 v[120:135], v[16:19], v[52:55], v[120:135]
    v_mfma_f32_32x32x16_bf16 v[136:151], v[20:23], v[48:51], v[136:151]
    v_mfma_f32_32x32x16_bf16 v[152:167], v[20:23], v[52:55], v[152:167]
    buffer_load_dwordx4 v[16:19], v2, s[40:43], s81 offen sc1
    buffer_load_dwordx4 v[20:23], v2, s[40:43], s81 offen offset:1024 sc1
    s_add_u32 s81, s81, 2048
    s_mov_b32 s85, 0
L_om_103:
    ds_read_b32 v6, v7
    s_add_u32 s85, s85, 1
    s_waitcnt lgkmcnt(0)
    v_readfirstlane_b32 s84, v6
    s_nop 0
    s_lshr_b32 s84, s84, s83
    s_bitcmp1_b32 s84, 2
    s_cbranch_scc1 L_omd_104
    s_cmp_gt_u32 s85, 1048576
    s_cbranch_scc1 L_omd_104
    s_sleep 1
    s_branch L_om_103
L_omd_104:
    buffer_load_dwordx4 v[72:75], v2, s[40:43], s78 offen sc1
    buffer_load_dwordx4 v[76:79], v2, s[40:43], s80 offen sc1
    s_add_u32 s78, s78, 1024
    s_add_u32 s80, s80, 1024
    buffer_load_dwordx4 v[80:83], v2, s[40:43], s78 offen sc1
    buffer_load_dwordx4 v[84:87], v2, s[40:43], s80 offen sc1
    s_add_u32 s78, s78, 1024
    s_add_u32 s80, s80, 1024
    s_waitcnt vmcnt(10)
    v_mfma_f32_32x32x16_bf16 v[104:119], v[24:27], v[56:59], v[104:119]
    v_mfma_f32_32x32x16_bf16 v[120:135], v[24:27], v[60:63], v[120:135]
    v_mfma_f32_32x32x16_bf16 v[136:151], v[28:31], v[56:59], v[136:151]
    v_mfma_f32_32x32x16_bf16 v[152:167], v[28:31], v[60:63], v[152:167]
    buffer_load_dwordx4 v[24:27], v2, s[40:43], s81 offen sc1
    buffer_load_dwordx4 v[28:31], v2, s[40:43], s81 offen offset:1024 sc1
    s_add_u32 s81, s81, 2048
    s_waitcnt vmcnt(10)
    v_mfma_f32_32x32x16_bf16 v[104:119], v[32:35], v[64:67], v[104:119]
    v_mfma_f32_32x32x16_bf16 v[120:135], v[32:35], v[68:71], v[120:135]
    v_mfma_f32_32x32x16_bf16 v[136:151], v[36:39], v[64:67], v[136:151]
    v_mfma_f32_32x32x16_bf16 v[152:167], v[36:39], v[68:71], v[152:167]
    buffer_load_dwordx4 v[32:35], v2, s[40:43], s81 offen sc1
    buffer_load_dwordx4 v[36:39], v2, s[40:43], s81 offen offset:1024 sc1
    s_add_u32 s81, s81, 2048
    s_mov_b32 s85, 0
L_om_105:
    ds_read_b32 v6, v7
    s_add_u32 s85, s85, 1
    s_waitcnt lgkmcnt(0)
    v_readfirstlane_b32 s84, v6
    s_nop 0
    s_lshr_b32 s84, s84, s83
    s_bitcmp1_b32 s84, 3
    s_cbranch_scc1 L_omd_106
    s_cmp_gt_u32 s85, 1048576
    s_cbranch_scc1 L_omd_106
    s_sleep 1
    s_branch L_om_105
L_omd_106:
    buffer_load_dwordx4 v[88:91], v2, s[40:43], s78 offen sc1
    buffer_load_dwordx4 v[92:95], v2, s[40:43], s80 offen sc1
    s_add_u32 s78, s78, 1024
    s_add_u32 s80, s80, 1024
    buffer_load_dwordx4 v[96:99], v2, s[40:43], s78 offen sc1
    buffer_load_dwordx4 v[100:103], v2, s[40:43], s80 offen sc1
    s_add_u32 s78, s78, 1024
    s_add_u32 s80, s80, 1024
    s_waitcnt vmcnt(10)
    v_mfma_f32_32x32x16_bf16 v[104:119], v[8:11], v[72:75], v[104:119]
    v_mfma_f32_32x32x16_bf16 v[120:135], v[8:11], v[76:79], v[120:135]
    v_mfma_f32_32x32x16_bf16 v[136:151], v[12:15], v[72:75], v[136:151]
    v_mfma_f32_32x32x16_bf16 v[152:167], v[12:15], v[76:79], v[152:167]
    s_waitcnt vmcnt(8)
    v_mfma_f32_32x32x16_bf16 v[104:119], v[16:19], v[80:83], v[104:119]
    v_mfma_f32_32x32x16_bf16 v[120:135], v[16:19], v[84:87], v[120:135]
    v_mfma_f32_32x32x16_bf16 v[136:151], v[20:23], v[80:83], v[136:151]
    v_mfma_f32_32x32x16_bf16 v[152:167], v[20:23], v[84:87], v[152:167]
    s_waitcnt vmcnt(2)
    v_mfma_f32_32x32x16_bf16 v[104:119], v[24:27], v[88:91], v[104:119]
    v_mfma_f32_32x32x16_bf16 v[120:135], v[24:27], v[92:95], v[120:135]
    v_mfma_f32_32x32x16_bf16 v[136:151], v[28:31], v[88:91], v[136:151]
    v_mfma_f32_32x32x16_bf16 v[152:167], v[28:31], v[92:95], v[152:167]
    s_waitcnt vmcnt(0)
    v_mfma_f32_32x32x16_bf16 v[104:119], v[32:35], v[96:99], v[104:119]
    v_mfma_f32_32x32x16_bf16 v[120:135], v[32:35], v[100:103], v[120:135]
    v_mfma_f32_32x32x16_bf16 v[136:151], v[36:39], v[96:99], v[136:151]
    v_mfma_f32_32x32x16_bf16 v[152:167], v[36:39], v[100:103], v[152:167]
    v_mov_b32 v4, 162904
    s_mov_b32 s85, 0
L_sp_107:
    ds_read_b32 v5, v4
    s_add_u32 s85, s85, 1
    s_waitcnt lgkmcnt(0)
    v_readfirstlane_b32 s84, v5
    s_nop 0
    s_cmp_ge_u32 s84, 8
    s_cbranch_scc1 L_spd_108
    s_cmp_gt_u32 s85, 1048576
    s_cbranch_scc1 L_spd_108
    s_sleep 1
    s_branch L_sp_107
L_spd_108:
    s_lshl_b32 s82, s6, 12
    v_add_u32 v7, s82, v2
    s_cmp_eq_u32 s6, 0
    s_cbranch_scc0 L_fin_110
    ds_write_b128 v7, v[120:123] offset:16384
    ds_write_b128 v7, v[124:127] offset:17408
    ds_write_b128 v7, v[128:131] offset:18432
    ds_write_b128 v7, v[132:135] offset:19456
    ds_write_b128 v7, v[136:139] offset:32768
    ds_write_b128 v7, v[140:143] offset:33792
    ds_write_b128 v7, v[144:147] offset:34816
    ds_write_b128 v7, v[148:151] offset:35840
    ds_write_b128 v7, v[152:155] offset:49152
    ds_write_b128 v7, v[156:159] offset:50176
    ds_write_b128 v7, v[160:163] offset:51200
    ds_write_b128 v7, v[164:167] offset:52224
    s_waitcnt lgkmcnt(0)
    s_barrier
    ds_read_b128 v[40:43], v2 offset:4096
    ds_read_b128 v[44:47], v2 offset:5120
    ds_read_b128 v[48:51], v2 offset:6144
    ds_read_b128 v[52:55], v2 offset:7168
    ds_read_b128 v[56:59], v2 offset:8192
    ds_read_b128 v[60:63], v2 offset:9216
    ds_read_b128 v[64:67], v2 offset:10240
    ds_read_b128 v[68:71], v2 offset:11264
    ds_read_b128 v[72:75], v2 offset:12288
    ds_read_b128 v[76:79], v2 offset:13312
    ds_read_b128 v[80:83], v2 offset:14336
    ds_read_b128 v[84:87], v2 offset:15360
    s_waitcnt lgkmcnt(8)
    v_pk_add_f32 v[104:105], v[104:105], v[40:41]
    v_pk_add_f32 v[106:107], v[106:107], v[42:43]
    v_pk_add_f32 v[108:109], v[108:109], v[44:45]
    v_pk_add_f32 v[110:111], v[110:111], v[46:47]
    v_pk_add_f32 v[112:113], v[112:113], v[48:49]
    v_pk_add_f32 v[114:115], v[114:115], v[50:51]
    v_pk_add_f32 v[116:117], v[116:117], v[52:53]
    v_pk_add_f32 v[118:119], v[118:119], v[54:55]
    s_waitcnt lgkmcnt(4)
    v_pk_add_f32 v[104:105], v[104:105], v[56:57]
    v_pk_add_f32 v[106:107], v[106:107], v[58:59]
    v_pk_add_f32 v[108:109], v[108:109], v[60:61]
    v_pk_add_f32 v[110:111], v[110:111], v[62:63]
    v_pk_add_f32 v[112:113], v[112:113], v[64:65]
    v_pk_add_f32 v[114:115], v[114:115], v[66:67]
    v_pk_add_f32 v[116:117], v[116:117], v[68:69]
    v_pk_add_f32 v[118:119], v[118:119], v[70:71]
    s_waitcnt lgkmcnt(0)
    v_pk_add_f32 v[104:105], v[104:105], v[72:73]
    v_pk_add_f32 v[106:107], v[106:107], v[74:75]
    v_pk_add_f32 v[108:109], v[108:109], v[76:77]
    v_pk_add_f32 v[110:111], v[110:111], v[78:79]
    v_pk_add_f32 v[112:113], v[112:113], v[80:81]
    v_pk_add_f32 v[114:115], v[114:115], v[82:83]
    v_pk_add_f32 v[116:117], v[116:117], v[84:85]
    v_pk_add_f32 v[118:119], v[118:119], v[86:87]
    v_cvt_pk_bf16_f32 v24, v104, v105
    v_cvt_pk_bf16_f32 v25, v106, v107
    v_cvt_pk_bf16_f32 v26, v108, v109
    v_cvt_pk_bf16_f32 v27, v110, v111
    v_cvt_pk_bf16_f32 v28, v112, v113
    v_cvt_pk_bf16_f32 v29, v114, v115
    v_cvt_pk_bf16_f32 v30, v116, v117
    v_cvt_pk_bf16_f32 v31, v118, v119
    v_permlane32_swap_b32 v24, v26
    v_permlane32_swap_b32 v25, v27
    v_permlane32_swap_b32 v28, v30
    v_permlane32_swap_b32 v29, v31
    buffer_store_dwordx4 v[24:27], v3, s[36:39], s77 offen nt
    buffer_store_dwordx4 v[28:31], v3, s[36:39], s77 offen offset:32 nt
    s_branch L_finj_113
L_fin_110:
    s_cmp_eq_u32 s6, 1
    s_cbranch_scc0 L_fin_111
    ds_write_b128 v7, v[104:107] offset:0
    ds_write_b128 v7, v[108:111] offset:1024
    ds_write_b128 v7, v[112:115] offset:2048
    ds_write_b128 v7, v[116:119] offset:3072
    ds_write_b128 v7, v[136:139] offset:32768
    ds_write_b128 v7, v[140:143] offset:33792
    ds_write_b128 v7, v[144:147] offset:34816
    ds_write_b128 v7, v[148:151] offset:35840
    ds_write_b128 v7, v[152:155] offset:49152
    ds_write_b128 v7, v[156:159] offset:50176
    ds_write_b128 v7, v[160:163] offset:51200
    ds_write_b128 v7, v[164:167] offset:52224
    s_waitcnt lgkmcnt(0)
    s_barrier
    ds_read_b128 v[40:43], v2 offset:16384
    ds_read_b128 v[44:47], v2 offset:17408
    ds_read_b128 v[48:51], v2 offset:18432
    ds_read_b128 v[52:55], v2 offset:19456
    ds_read_b128 v[56:59], v2 offset:24576
    ds_read_b128 v[60:63], v2 offset:25600
    ds_read_b128 v[64:67], v2 offset:26624
    ds_read_b128 v[68:71], v2 offset:27648
    ds_read_b128 v[72:75], v2 offset:28672
    ds_read_b128 v[76:79], v2 offset:29696
    ds_read_b128 v[80:83], v2 offset:30720
    ds_read_b128 v[84:87], v2 offset:31744
    s_waitcnt lgkmcnt(8)
    v_pk_add_f32 v[120:121], v[120:121], v[40:41]
    v_pk_add_f32 v[122:123], v[122:123], v[42:43]
    v_pk_add_f32 v[124:125], v[124:125], v[44:45]
    v_pk_add_f32 v[126:127], v[126:127], v[46:47]
    v_pk_add_f32 v[128:129], v[128:129], v[48:49]
    v_pk_add_f32 v[130:131], v[130:131], v[50:51]
    v_pk_add_f32 v[132:133], v[132:133], v[52:53]
    v_pk_add_f32 v[134:135], v[134:135], v[54:55]
    s_waitcnt lgkmcnt(4)
    v_pk_add_f32 v[120:121], v[120:121], v[56:57]
    v_pk_add_f32 v[122:123], v[122:123], v[58:59]
    v_pk_add_f32 v[124:125], v[124:125], v[60:61]
    v_pk_add_f32 v[126:127], v[126:127], v[62:63]
    v_pk_add_f32 v[128:129], v[128:129], v[64:65]
    v_pk_add_f32 v[130:131], v[130:131], v[66:67]
    v_pk_add_f32 v[132:133], v[132:133], v[68:69]
    v_pk_add_f32 v[134:135], v[134:135], v[70:71]
    s_waitcnt lgkmcnt(0)
    v_pk_add_f32 v[120:121], v[120:121], v[72:73]
    v_pk_add_f32 v[122:123], v[122:123], v[74:75]
    v_pk_add_f32 v[124:125], v[124:125], v[76:77]
    v_pk_add_f32 v[126:127], v[126:127], v[78:79]
    v_pk_add_f32 v[128:129], v[128:129], v[80:81]
    v_pk_add_f32 v[130:131], v[130:131], v[82:83]
    v_pk_add_f32 v[132:133], v[132:133], v[84:85]
    v_pk_add_f32 v[134:135], v[134:135], v[86:87]
    v_cvt_pk_bf16_f32 v24, v120, v121
    v_cvt_pk_bf16_f32 v25, v122, v123
    v_cvt_pk_bf16_f32 v26, v124, v125
    v_cvt_pk_bf16_f32 v27, v126, v127
    v_cvt_pk_bf16_f32 v28, v128, v129
    v_cvt_pk_bf16_f32 v29, v130, v131
    v_cvt_pk_bf16_f32 v30, v132, v133
    v_cvt_pk_bf16_f32 v31, v134, v135
    v_permlane32_swap_b32 v24, v26
    v_permlane32_swap_b32 v25, v27
    v_permlane32_swap_b32 v28, v30
    v_permlane32_swap_b32 v29, v31
    buffer_store_dwordx4 v[24:27], v3, s[36:39], s77 offen nt
    buffer_store_dwordx4 v[28:31], v3, s[36:39], s77 offen offset:32 nt
    s_branch L_finj_113
L_fin_111:
    s_cmp_eq_u32 s6, 2
    s_cbranch_scc0 L_fin_112
    ds_write_b128 v7, v[104:107] offset:0
    ds_write_b128 v7, v[108:111] offset:1024
    ds_write_b128 v7, v[112:115] offset:2048
    ds_write_b128 v7, v[116:119] offset:3072
    ds_write_b128 v7, v[120:123] offset:16384
    ds_write_b128 v7, v[124:127] offset:17408
    ds_write_b128 v7, v[128:131] offset:18432
    ds_write_b128 v7, v[132:135] offset:19456
    ds_write_b128 v7, v[152:155] offset:49152
    ds_write_b128 v7, v[156:159] offset:50176
    ds_write_b128 v7, v[160:163] offset:51200
    ds_write_b128 v7, v[164:167] offset:52224
    s_waitcnt lgkmcnt(0)
    s_barrier
    ds_read_b128 v[40:43], v2 offset:32768
    ds_read_b128 v[44:47], v2 offset:33792
    ds_read_b128 v[48:51], v2 offset:34816
    ds_read_b128 v[52:55], v2 offset:35840
    ds_read_b128 v[56:59], v2 offset:36864
    ds_read_b128 v[60:63], v2 offset:37888
    ds_read_b128 v[64:67], v2 offset:38912
    ds_read_b128 v[68:71], v2 offset:39936
    ds_read_b128 v[72:75], v2 offset:45056
    ds_read_b128 v[76:79], v2 offset:46080
    ds_read_b128 v[80:83], v2 offset:47104
    ds_read_b128 v[84:87], v2 offset:48128
    s_waitcnt lgkmcnt(8)
    v_pk_add_f32 v[136:137], v[136:137], v[40:41]
    v_pk_add_f32 v[138:139], v[138:139], v[42:43]
    v_pk_add_f32 v[140:141], v[140:141], v[44:45]
    v_pk_add_f32 v[142:143], v[142:143], v[46:47]
    v_pk_add_f32 v[144:145], v[144:145], v[48:49]
    v_pk_add_f32 v[146:147], v[146:147], v[50:51]
    v_pk_add_f32 v[148:149], v[148:149], v[52:53]
    v_pk_add_f32 v[150:151], v[150:151], v[54:55]
    s_waitcnt lgkmcnt(4)
    v_pk_add_f32 v[136:137], v[136:137], v[56:57]
    v_pk_add_f32 v[138:139], v[138:139], v[58:59]
    v_pk_add_f32 v[140:141], v[140:141], v[60:61]
    v_pk_add_f32 v[142:143], v[142:143], v[62:63]
    v_pk_add_f32 v[144:145], v[144:145], v[64:65]
    v_pk_add_f32 v[146:147], v[146:147], v[66:67]
    v_pk_add_f32 v[148:149], v[148:149], v[68:69]
    v_pk_add_f32 v[150:151], v[150:151], v[70:71]
    s_waitcnt lgkmcnt(0)
    v_pk_add_f32 v[136:137], v[136:137], v[72:73]
    v_pk_add_f32 v[138:139], v[138:139], v[74:75]
    v_pk_add_f32 v[140:141], v[140:141], v[76:77]
    v_pk_add_f32 v[142:143], v[142:143], v[78:79]
    v_pk_add_f32 v[144:145], v[144:145], v[80:81]
    v_pk_add_f32 v[146:147], v[146:147], v[82:83]
    v_pk_add_f32 v[148:149], v[148:149], v[84:85]
    v_pk_add_f32 v[150:151], v[150:151], v[86:87]
    v_cvt_pk_bf16_f32 v24, v136, v137
    v_cvt_pk_bf16_f32 v25, v138, v139
    v_cvt_pk_bf16_f32 v26, v140, v141
    v_cvt_pk_bf16_f32 v27, v142, v143
    v_cvt_pk_bf16_f32 v28, v144, v145
    v_cvt_pk_bf16_f32 v29, v146, v147
    v_cvt_pk_bf16_f32 v30, v148, v149
    v_cvt_pk_bf16_f32 v31, v150, v151
    v_permlane32_swap_b32 v24, v26
    v_permlane32_swap_b32 v25, v27
    v_permlane32_swap_b32 v28, v30
    v_permlane32_swap_b32 v29, v31
    buffer_store_dwordx4 v[24:27], v3, s[36:39], s77 offen nt
    buffer_store_dwordx4 v[28:31], v3, s[36:39], s77 offen offset:32 nt
    s_branch L_finj_113
L_fin_112:
    ds_write_b128 v7, v[104:107] offset:0
    ds_write_b128 v7, v[108:111] offset:1024
    ds_write_b128 v7, v[112:115] offset:2048
    ds_write_b128 v7, v[116:119] offset:3072
    ds_write_b128 v7, v[120:123] offset:16384
    ds_write_b128 v7, v[124:127] offset:17408
    ds_write_b128 v7, v[128:131] offset:18432
    ds_write_b128 v7, v[132:135] offset:19456
    ds_write_b128 v7, v[136:139] offset:32768
    ds_write_b128 v7, v[140:143] offset:33792
    ds_write_b128 v7, v[144:147] offset:34816
    ds_write_b128 v7, v[148:151] offset:35840
    s_waitcnt lgkmcnt(0)
    s_barrier
    ds_read_b128 v[40:43], v2 offset:49152
    ds_read_b128 v[44:47], v2 offset:50176
    ds_read_b128 v[48:51], v2 offset:51200
    ds_read_b128 v[52:55], v2 offset:52224
    ds_read_b128 v[56:59], v2 offset:53248
    ds_read_b128 v[60:63], v2 offset:54272
    ds_read_b128 v[64:67], v2 offset:55296
    ds_read_b128 v[68:71], v2 offset:56320
    ds_read_b128 v[72:75], v2 offset:57344
    ds_read_b128 v[76:79], v2 offset:58368
    ds_read_b128 v[80:83], v2 offset:59392
    ds_read_b128 v[84:87], v2 offset:60416
    s_waitcnt lgkmcnt(8)
    v_pk_add_f32 v[152:153], v[152:153], v[40:41]
    v_pk_add_f32 v[154:155], v[154:155], v[42:43]
    v_pk_add_f32 v[156:157], v[156:157], v[44:45]
    v_pk_add_f32 v[158:159], v[158:159], v[46:47]
    v_pk_add_f32 v[160:161], v[160:161], v[48:49]
    v_pk_add_f32 v[162:163], v[162:163], v[50:51]
    v_pk_add_f32 v[164:165], v[164:165], v[52:53]
    v_pk_add_f32 v[166:167], v[166:167], v[54:55]
    s_waitcnt lgkmcnt(4)
    v_pk_add_f32 v[152:153], v[152:153], v[56:57]
    v_pk_add_f32 v[154:155], v[154:155], v[58:59]
    v_pk_add_f32 v[156:157], v[156:157], v[60:61]
    v_pk_add_f32 v[158:159], v[158:159], v[62:63]
    v_pk_add_f32 v[160:161], v[160:161], v[64:65]
    v_pk_add_f32 v[162:163], v[162:163], v[66:67]
    v_pk_add_f32 v[164:165], v[164:165], v[68:69]
    v_pk_add_f32 v[166:167], v[166:167], v[70:71]
    s_waitcnt lgkmcnt(0)
    v_pk_add_f32 v[152:153], v[152:153], v[72:73]
    v_pk_add_f32 v[154:155], v[154:155], v[74:75]
    v_pk_add_f32 v[156:157], v[156:157], v[76:77]
    v_pk_add_f32 v[158:159], v[158:159], v[78:79]
    v_pk_add_f32 v[160:161], v[160:161], v[80:81]
    v_pk_add_f32 v[162:163], v[162:163], v[82:83]
    v_pk_add_f32 v[164:165], v[164:165], v[84:85]
    v_pk_add_f32 v[166:167], v[166:167], v[86:87]
    v_cvt_pk_bf16_f32 v24, v152, v153
    v_cvt_pk_bf16_f32 v25, v154, v155
    v_cvt_pk_bf16_f32 v26, v156, v157
    v_cvt_pk_bf16_f32 v27, v158, v159
    v_cvt_pk_bf16_f32 v28, v160, v161
    v_cvt_pk_bf16_f32 v29, v162, v163
    v_cvt_pk_bf16_f32 v30, v164, v165
    v_cvt_pk_bf16_f32 v31, v166, v167
    v_permlane32_swap_b32 v24, v26
    v_permlane32_swap_b32 v25, v27
    v_permlane32_swap_b32 v28, v30
    v_permlane32_swap_b32 v29, v31
    buffer_store_dwordx4 v[24:27], v3, s[36:39], s77 offen nt
    buffer_store_dwordx4 v[28:31], v3, s[36:39], s77 offen offset:32 nt
L_finj_113:
    s_or_b32 s75, s2, s6
    s_cmp_eq_u32 s75, 0
    s_cbranch_scc0 L_114
    s_mov_b64 exec, 1
    v_mov_b32 v20, 196608
    v_mov_b32 v22, s44
    v_mov_b32 v23, s45
    buffer_store_dwordx2 v[22:23], v20, s[40:43], 0 offen
L_114:
L_auxexit_83:
    s_endpgm
L_exit:
    s_endpgm
L_code_end:

.section .rodata,"a"
.p2align 6
.amdhsa_kernel parallel_sum__mha_block__dense_activation_squared_relu__prompt_kernel
  .amdhsa_next_free_vgpr 168
  .amdhsa_next_free_sgpr 102
  .amdhsa_accum_offset 168
  .amdhsa_group_segment_fixed_size 0
  .amdhsa_kernarg_size 88
  .amdhsa_user_sgpr_count 2
  .amdhsa_user_sgpr_kernarg_segment_ptr 1
  .amdhsa_system_sgpr_workgroup_id_x 1
.end_amdhsa_kernel
```
